```python
import torch

def _softmax(x, axis=-1):
    return torch.softmax(x, dim=axis)
def _gelu(x):
    return torch.nn.functional.gelu(x, approximate="tanh")
def _silu(x):
    return torch.nn.functional.silu(x)
def _sigmoid(x):
    return torch.sigmoid(x)
def _layernorm(x, axis=-1, eps=1e-5):
    m = x.mean(dim=axis, keepdim=True)
    v = x.var(dim=axis, keepdim=True, unbiased=False)
    return (x - m) / torch.sqrt(v + eps)
def _scatter_add(tgt, idx, src, axis=0):
    return tgt.clone().index_add_(axis, idx, src)
def _segment_sum(src, seg, n):
    out = torch.zeros((n,) + src.shape[1:], dtype=src.dtype)
    return out.index_add_(0, seg, src)
def _pad(x, pw):
    flat = tuple(v for pair in reversed(pw) for v in pair)
    return torch.nn.functional.pad(x, flat)

kernel_name = 'gated_mix__ssm_conv_s4__swiglu_ffn__prompt'

def setup_inputs():

    _w = (lambda a: (lambda t: t.to(torch.bfloat16) if t.is_floating_point() else t)(torch.as_tensor(a)))
    def _A_setup():
        B, L, D, N = 1, 2048, 640, 192
        A_re = -(lambda _x: torch.exp(torch.as_tensor(_x)))((lambda *s: torch.randn(*s, dtype=torch.bfloat16) * 3.2)(D, N))
        A_im = torch.pi * (lambda *s: torch.randn(*s, dtype=torch.bfloat16) * 0.05)(D, N)
        B_re = (lambda *s: torch.randn(*s, dtype=torch.bfloat16) * 0.1)(D, N)
        B_im = (lambda *s: torch.randn(*s, dtype=torch.bfloat16) * 0.1)(D, N)
        C_re = (lambda *s: torch.randn(*s, dtype=torch.bfloat16) * 0.1)(D, N)
        C_im = (lambda *s: torch.randn(*s, dtype=torch.bfloat16) * 0.1)(D, N)
        log_dt = (lambda *s: torch.randn(*s, dtype=torch.bfloat16) * 0.05)(D) * 0.5 - 4.0
        Dskip = (lambda *s: torch.randn(*s, dtype=torch.bfloat16) * 0.05)(D)
        return {
            "u": _w((lambda *s: torch.randn(*s, dtype=torch.bfloat16) * 0.05)(B, L, D)),
            "A_re": _w(A_re),
            "A_im": _w(A_im),
            "B_re": _w(B_re),
            "B_im": _w(B_im),
            "C_re": _w(C_re),
            "C_im": _w(C_im),
            "log_dt": _w(log_dt),
            "Dskip": _w(Dskip),
        }
    _A_in = _A_setup()

    def _B_setup():
        B, S, D, F = 1, 2048, 640, 1536
        return {
            "x": _w((lambda *s: torch.randn(*s, dtype=torch.bfloat16) * 0.05)(B, S, D)),
            "w_gate": _w((lambda *s: torch.randn(*s, dtype=torch.bfloat16) * 0.05)(D, F)),
            "w_up": _w((lambda *s: torch.randn(*s, dtype=torch.bfloat16) * 0.05)(D, F)),
            "w_down": _w((lambda *s: torch.randn(*s, dtype=torch.bfloat16) * 0.05)(F, D)),
        }
    _B_in = _B_setup()

    return {
        "A_u": _A_in["u"],
        "A_A_re": _A_in["A_re"],
        "A_A_im": _A_in["A_im"],
        "A_B_re": _A_in["B_re"],
        "A_B_im": _A_in["B_im"],
        "A_C_re": _A_in["C_re"],
        "A_C_im": _A_in["C_im"],
        "A_log_dt": _A_in["log_dt"],
        "A_Dskip": _A_in["Dskip"],
        "B_x": _B_in["x"],
        "B_w_gate": _B_in["w_gate"],
        "B_w_up": _B_in["w_up"],
        "B_w_down": _B_in["w_down"],
        "gate_w": _w((lambda *s: torch.randn(*s, dtype=torch.bfloat16) * 0.05)(640) * 16.0),
    }

def reference(A_u, A_A_re, A_A_im, A_B_re, A_B_im, A_C_re, A_C_im, A_log_dt, A_Dskip, B_x, B_w_gate, B_w_up, B_w_down, gate_w):
    def _A_ref(u, A_re, A_im, B_re, B_im, C_re, C_im, log_dt, Dskip):
        Bsz, L, D = u.shape
        dt = torch.exp(log_dt)[:, None]
        A = A_re + 1j * A_im
        Bc = B_re + 1j * B_im
        Cc = C_re + 1j * C_im
        logdA = dt * A
        dB = dt * Bc
        l = (lambda x, dt: x.to(dt))(torch.arange(L), A_re.dtype)
        P = torch.exp(logdA[:, :, None] * l[None, None, :])
        K = torch.einsum("dn,dnl,dn->dl", Cc, P, dB).real
        L2 = 2 * L
        Kp = _pad(K, ((0, 0), (0, L)))
        up = (lambda x, *d: x.permute(*d))(u, 0, 2, 1)
        up = _pad(up, ((0, 0), (0, 0), (0, L)))
        Kf = (lambda x, axes=(-2,-1): torch.fft.rfft2(x.float(), dim=axes))(Kp[:, None, :], axes=(-2, -1))
        Uf = (lambda x, axes=(-2,-1): torch.fft.rfft2(x.float(), dim=axes))(up[:, :, None, :], axes=(-2, -1))
        Yf = Uf * Kf[None, :, :, :]
        y = (lambda x, s, axes=(-2,-1): torch.fft.irfft2(x, s=s, dim=axes).to(torch.bfloat16))(Yf, (1, L2), axes=(-2, -1))[:, :, 0, :L]
        y = (lambda x, *d: x.permute(*d))(y, 0, 2, 1) + u * Dskip[None, None, :]
        return y

    def _B_ref(x, w_gate, w_up, w_down):
        g = _silu(x @ w_gate)
        u = x @ w_up
        return (g * u) @ w_down

    x = A_u
    g = _sigmoid((x * gate_w).sum(-1, keepdims=True))
    a = _A_ref(x, A_A_re, A_A_im, A_B_re, A_B_im, A_C_re, A_C_im, A_log_dt, A_Dskip)
    b = _B_ref(x, B_w_gate, B_w_up, B_w_down)
    return g * a + (1 - g) * b
```

```asm
; @launch grid=(512,1,1) block=(256,1,1) lds=81920
.amdgcn_target "amdgcn-amd-amdhsa--gfx950"
.text
.globl gated_mix__ssm_conv_s4__swiglu_ffn__prompt_kernel
.p2align 8
.type gated_mix__ssm_conv_s4__swiglu_ffn__prompt_kernel,@function
gated_mix__ssm_conv_s4__swiglu_ffn__prompt_kernel:
s_cmp_ge_u32 s2, 512
s_cbranch_scc1 L_exit
v_lshrrev_b32 v1, 6, v0
s_nop 0
v_readfirstlane_b32 s4, v1
s_and_b32 s5, s2, 7
s_lshr_b32 s7, s2, 3
s_lshr_b32 s3, s7, 5
s_xor_b32 s6, s7, s3
s_and_b32 s34, s6, 1
s_and_b32 s6, s7, 31
s_lshr_b32 s6, s6, 1
s_lshl_b32 s3, s3, 4
s_or_b32 s6, s6, s3
s_cmp_eq_u32 s34, 1
s_cbranch_scc1 L_ssm
s_or_b32 s3, s5, s6
s_or_b32 s3, s3, s4
s_cmp_eq_u32 s3, 0
s_cbranch_scc0 L_nonw
s_load_dwordx2 s[60:61], s[0:1], 120
s_memrealtime s[62:63]
s_waitcnt lgkmcnt(0)
s_or_b32 s58, s62, 1
v_mov_b32 v250, 0
v_mov_b32 v251, s58
global_store_dword v250, v251, s[60:61] sc1
L_nonw:
s_lshr_b32 s40, s5, 2
s_lshl_b32 s40, s40, 3
s_and_b32 s7, s6, 7
s_add_u32 s40, s40, s7
s_and_b32 s41, s5, 3
s_lshl_b32 s41, s41, 2
s_lshr_b32 s7, s6, 3
s_add_u32 s41, s41, s7
s_load_dwordx2 s[8:9], s[0:1], 0
s_load_dwordx4 s[20:23], s[0:1], 80
s_load_dwordx2 s[16:17], s[0:1], 128
v_and_b32 v1, 63, v0
v_lshrrev_b32 v56, 3, v1
v_lshrrev_b32 v57, 1, v56
v_and_b32 v57, 7, v57
v_and_b32 v58, 7, v1
v_xor_b32 v57, v57, v58
v_lshlrev_b32 v57, 4, v57
v_mul_u32_u24 v56, 1280, v56
v_add_u32 v2, v56, v57
v_lshrrev_b32 v56, 3, v1
v_add_u32 v56, 8, v56
v_lshrrev_b32 v57, 1, v56
v_and_b32 v57, 7, v57
v_and_b32 v58, 7, v1
v_xor_b32 v57, v57, v58
v_lshlrev_b32 v57, 4, v57
v_mul_u32_u24 v56, 1280, v56
v_add_u32 v3, v56, v57
s_lshl_b32 s24, s40, 7
s_lshl_b32 s25, s4, 5
s_add_u32 s24, s24, s25
s_mul_i32 s24, s24, 1280
v_add_u32 v2, s24, v2
v_add_u32 v3, s24, v3
s_lshr_b32 s26, s4, 1
s_and_b32 s27, s4, 1
s_mul_i32 s28, s27, 192
s_lshl_b32 s29, s26, 1
s_mul_i32 s30, s41, 192
s_mov_b32 s31, 43691
v_add_u32 v56, s28, v1
v_mul_u32_u24 v57, s31, v56
v_lshrrev_b32 v57, 19, v57
v_mul_u32_u24 v58, 12, v57
v_sub_u32 v58, v56, v58
v_xor_b32 v58, s29, v58
v_lshlrev_b32 v58, 4, v58
v_mul_u32_u24 v57, 3072, v57
v_add3_u32 v4, v57, v58, s30
v_add_u32 v56, s28, v1
v_add_u32 v56, 64, v56
v_mul_u32_u24 v57, s31, v56
v_lshrrev_b32 v57, 19, v57
v_mul_u32_u24 v58, 12, v57
v_sub_u32 v58, v56, v58
v_xor_b32 v58, s29, v58
v_lshlrev_b32 v58, 4, v58
v_mul_u32_u24 v57, 3072, v57
v_add3_u32 v5, v57, v58, s30
v_add_u32 v56, s28, v1
v_add_u32 v56, 128, v56
v_mul_u32_u24 v57, s31, v56
v_lshrrev_b32 v57, 19, v57
v_mul_u32_u24 v58, 12, v57
v_sub_u32 v58, v56, v58
v_xor_b32 v58, s29, v58
v_lshlrev_b32 v58, 4, v58
v_mul_u32_u24 v57, 3072, v57
v_add3_u32 v6, v57, v58, s30
s_mul_i32 s34, s26, 6144
s_mul_i32 s35, s27, 3072
s_add_u32 s34, s34, s35
s_lshl_b32 s35, s4, 12
s_add_u32 s35, s35, 49152
s_waitcnt lgkmcnt(0)
s_mov_b32 s10, 0x280000
s_mov_b32 s11, 0x20000
s_cmp_eq_u32 s26, 0
s_cselect_b32 s12, s20, s22
s_cselect_b32 s13, s21, s23
s_mov_b32 s14, 1966080
s_mov_b32 s15, 0x20000
s_mov_b32 s18, 0x600000
s_mov_b32 s19, 0x20000
s_setprio 3
s_and_b32 s54, s6, 7
s_lshr_b32 s55, s6, 3
s_add_u32 s54, s54, s55
s_mul_i32 s55, s54, 13108
s_lshr_b32 s55, s55, 16
s_mul_i32 s55, s55, 5
s_sub_u32 s54, s54, s55
s_mul_i32 s54, s54, 2
s_mul_i32 s52, s54, 196608
s_lshl_b32 s53, s54, 7
s_mov_b32 s37, s53
s_add_u32 s53, s53, 128
s_cmp_ge_u32 s53, 1280
s_cselect_b32 s53, 0, s53
s_add_u32 m0, s35, 0
s_nop 0
buffer_load_dwordx4 v2, s[8:11], s37 offen lds
s_add_u32 m0, s35, 1024
s_nop 0
buffer_load_dwordx4 v3, s[8:11], s37 offen lds
s_add_u32 s37, s37, 20480
s_add_u32 m0, s35, 2048
s_nop 0
buffer_load_dwordx4 v2, s[8:11], s37 offen lds
s_add_u32 m0, s35, 3072
s_nop 0
buffer_load_dwordx4 v3, s[8:11], s37 offen lds
s_mov_b32 s36, s52
s_add_u32 s52, s52, 98304
s_cmp_ge_u32 s52, 1966080
s_cselect_b32 s52, 0, s52
s_add_u32 m0, s34, 0
s_nop 0
buffer_load_dwordx4 v4, s[12:15], s36 offen lds
s_add_u32 m0, s34, 1024
s_nop 0
buffer_load_dwordx4 v5, s[12:15], s36 offen lds
s_add_u32 m0, s34, 2048
s_nop 0
buffer_load_dwordx4 v6, s[12:15], s36 offen lds
v_lshrrev_b32 v56, 4, v1
v_and_b32 v57, 1, v56
v_lshrrev_b32 v58, 1, v56
v_bfe_u32 v59, v1, 2, 2
v_lshl_add_u32 v58, v58, 3, v59
v_mul_u32_u24 v58, 192, v58
v_mul_u32_u24 v59, 6144, v57
v_add_u32 v58, v58, v59
v_and_b32 v59, 1, v1
v_lshl_add_u32 v58, v59, 3, v58
v_bfe_u32 v59, v1, 1, 1
v_lshlrev_b32 v57, 1, v57
s_mul_i32 s32, s26, 6
v_add_u32 v60, s32, v59
v_xor_b32 v60, v60, v57
v_lshl_add_u32 v7, v60, 4, v58
v_add_u32 v60, s32, v59
v_add_u32 v60, 2, v60
v_xor_b32 v60, v60, v57
v_lshl_add_u32 v8, v60, 4, v58
v_add_u32 v60, s32, v59
v_add_u32 v60, 4, v60
v_xor_b32 v60, v60, v57
v_lshl_add_u32 v9, v60, 4, v58
v_and_b32 v56, 31, v1
s_lshl_b32 s33, s27, 6
v_add_u32 v56, s33, v56
v_bfe_u32 v57, v56, 1, 3
v_lshrrev_b32 v58, 5, v1
v_lshlrev_b32 v56, 7, v56
v_add_u32 v56, 49152, v56
v_add_u32 v59, 0, v58
v_xor_b32 v59, v59, v57
v_lshl_add_u32 v10, v59, 4, v56
v_add_u32 v59, 2, v58
v_xor_b32 v59, v59, v57
v_lshl_add_u32 v11, v59, 4, v56
v_add_u32 v59, 4, v58
v_xor_b32 v59, v59, v57
v_lshl_add_u32 v12, v59, 4, v56
v_add_u32 v59, 6, v58
v_xor_b32 v59, v59, v57
v_lshl_add_u32 v13, v59, 4, v56
v_bfe_u32 v56, v1, 4, 1
v_mul_u32_u24 v56, 49152, v56
v_lshlrev_b32 v57, 8, v58
v_and_b32 v59, 15, v1
v_lshlrev_b32 v59, 4, v59
v_add3_u32 v14, v56, v57, v59
v_mov_b32 v96, 0
v_mov_b32 v97, 0
v_mov_b32 v98, 0
v_mov_b32 v99, 0
v_mov_b32 v100, 0
v_mov_b32 v101, 0
v_mov_b32 v102, 0
v_mov_b32 v103, 0
v_mov_b32 v104, 0
v_mov_b32 v105, 0
v_mov_b32 v106, 0
v_mov_b32 v107, 0
v_mov_b32 v108, 0
v_mov_b32 v109, 0
v_mov_b32 v110, 0
v_mov_b32 v111, 0
v_mov_b32 v112, 0
v_mov_b32 v113, 0
v_mov_b32 v114, 0
v_mov_b32 v115, 0
v_mov_b32 v116, 0
v_mov_b32 v117, 0
v_mov_b32 v118, 0
v_mov_b32 v119, 0
v_mov_b32 v120, 0
v_mov_b32 v121, 0
v_mov_b32 v122, 0
v_mov_b32 v123, 0
v_mov_b32 v124, 0
v_mov_b32 v125, 0
v_mov_b32 v126, 0
v_mov_b32 v127, 0
v_mov_b32 v128, 0
v_mov_b32 v129, 0
v_mov_b32 v130, 0
v_mov_b32 v131, 0
v_mov_b32 v132, 0
v_mov_b32 v133, 0
v_mov_b32 v134, 0
v_mov_b32 v135, 0
v_mov_b32 v136, 0
v_mov_b32 v137, 0
v_mov_b32 v138, 0
v_mov_b32 v139, 0
v_mov_b32 v140, 0
v_mov_b32 v141, 0
v_mov_b32 v142, 0
v_mov_b32 v143, 0
v_mov_b32 v144, 0
v_mov_b32 v145, 0
v_mov_b32 v146, 0
v_mov_b32 v147, 0
v_mov_b32 v148, 0
v_mov_b32 v149, 0
v_mov_b32 v150, 0
v_mov_b32 v151, 0
v_mov_b32 v152, 0
v_mov_b32 v153, 0
v_mov_b32 v154, 0
v_mov_b32 v155, 0
v_mov_b32 v156, 0
v_mov_b32 v157, 0
v_mov_b32 v158, 0
v_mov_b32 v159, 0
v_mov_b32 v160, 0
v_mov_b32 v161, 0
v_mov_b32 v162, 0
v_mov_b32 v163, 0
v_mov_b32 v164, 0
v_mov_b32 v165, 0
v_mov_b32 v166, 0
v_mov_b32 v167, 0
v_mov_b32 v168, 0
v_mov_b32 v169, 0
v_mov_b32 v170, 0
v_mov_b32 v171, 0
v_mov_b32 v172, 0
v_mov_b32 v173, 0
v_mov_b32 v174, 0
v_mov_b32 v175, 0
v_mov_b32 v176, 0
v_mov_b32 v177, 0
v_mov_b32 v178, 0
v_mov_b32 v179, 0
v_mov_b32 v180, 0
v_mov_b32 v181, 0
v_mov_b32 v182, 0
v_mov_b32 v183, 0
v_mov_b32 v184, 0
v_mov_b32 v185, 0
v_mov_b32 v186, 0
v_mov_b32 v187, 0
v_mov_b32 v188, 0
v_mov_b32 v189, 0
v_mov_b32 v190, 0
v_mov_b32 v191, 0
s_mov_b32 s36, s52
s_add_u32 s52, s52, 98304
s_cmp_ge_u32 s52, 1966080
s_cselect_b32 s52, 0, s52
s_add_u32 m0, s34, 12288
s_nop 0
buffer_load_dwordx4 v4, s[12:15], s36 offen lds
s_add_u32 m0, s34, 13312
s_nop 0
buffer_load_dwordx4 v5, s[12:15], s36 offen lds
s_add_u32 m0, s34, 14336
s_nop 0
buffer_load_dwordx4 v6, s[12:15], s36 offen lds
s_mov_b32 s37, s53
s_add_u32 s53, s53, 128
s_cmp_ge_u32 s53, 1280
s_cselect_b32 s53, 0, s53
s_add_u32 m0, s35, 16384
s_nop 0
buffer_load_dwordx4 v2, s[8:11], s37 offen lds
s_add_u32 m0, s35, 17408
s_nop 0
buffer_load_dwordx4 v3, s[8:11], s37 offen lds
s_add_u32 s37, s37, 20480
s_add_u32 m0, s35, 18432
s_nop 0
buffer_load_dwordx4 v2, s[8:11], s37 offen lds
s_add_u32 m0, s35, 19456
s_nop 0
buffer_load_dwordx4 v3, s[8:11], s37 offen lds
s_mov_b32 s36, s52
s_add_u32 s52, s52, 98304
s_cmp_ge_u32 s52, 1966080
s_cselect_b32 s52, 0, s52
s_add_u32 m0, s34, 24576
s_nop 0
buffer_load_dwordx4 v4, s[12:15], s36 offen lds
s_add_u32 m0, s34, 25600
s_nop 0
buffer_load_dwordx4 v5, s[12:15], s36 offen lds
s_add_u32 m0, s34, 26624
s_nop 0
buffer_load_dwordx4 v6, s[12:15], s36 offen lds
s_mov_b32 s36, s52
s_add_u32 s52, s52, 98304
s_cmp_ge_u32 s52, 1966080
s_cselect_b32 s52, 0, s52
s_add_u32 m0, s34, 36864
s_nop 0
buffer_load_dwordx4 v4, s[12:15], s36 offen lds
s_add_u32 m0, s34, 37888
s_nop 0
buffer_load_dwordx4 v5, s[12:15], s36 offen lds
s_add_u32 m0, s34, 38912
s_nop 0
buffer_load_dwordx4 v6, s[12:15], s36 offen lds
s_load_dwordx2 s[60:61], s[0:1], 120
s_load_dwordx2 s[32:33], s[0:1], 128
v_mov_b32 v250, 0
s_waitcnt lgkmcnt(0)
s_cmp_eq_u32 s4, 0
s_cbranch_scc0 L_n0_1
global_load_dword v251, v250, s[60:61] sc1
L_n0_1:
s_waitcnt vmcnt(13)
s_barrier
ds_read_b64_tr_b16 v[16:17], v7 offset:0
ds_read_b64_tr_b16 v[18:19], v7 offset:768
ds_read_b128 v[28:31], v10 offset:0
ds_read_b128 v[32:35], v10 offset:4096
ds_read_b64_tr_b16 v[20:21], v8 offset:0
ds_read_b64_tr_b16 v[22:23], v8 offset:768
ds_read_b64_tr_b16 v[24:25], v9 offset:0
ds_read_b64_tr_b16 v[26:27], v9 offset:768
ds_read_b64_tr_b16 v[36:37], v7 offset:3072
ds_read_b64_tr_b16 v[38:39], v7 offset:3840
ds_read_b128 v[48:51], v11 offset:0
ds_read_b128 v[52:55], v11 offset:4096
ds_read_b64_tr_b16 v[40:41], v8 offset:3072
ds_read_b64_tr_b16 v[42:43], v8 offset:3840
ds_read_b64_tr_b16 v[44:45], v9 offset:3072
ds_read_b64_tr_b16 v[46:47], v9 offset:3840
s_waitcnt lgkmcnt(13)
v_mfma_f32_32x32x16_bf16 v[96:111], v[16:19], v[28:31], v[96:111]
s_waitcnt lgkmcnt(12)
v_mfma_f32_32x32x16_bf16 v[112:127], v[16:19], v[32:35], v[112:127]
s_waitcnt lgkmcnt(10)
v_mfma_f32_32x32x16_bf16 v[128:143], v[20:23], v[28:31], v[128:143]
v_mfma_f32_32x32x16_bf16 v[144:159], v[20:23], v[32:35], v[144:159]
s_waitcnt lgkmcnt(8)
v_mfma_f32_32x32x16_bf16 v[160:175], v[24:27], v[28:31], v[160:175]
v_mfma_f32_32x32x16_bf16 v[176:191], v[24:27], v[32:35], v[176:191]
s_waitcnt lgkmcnt(0)
s_waitcnt vmcnt(10)
s_barrier
ds_read_b64_tr_b16 v[200:201], v7 offset:12288
ds_read_b64_tr_b16 v[202:203], v7 offset:13056
ds_read_b128 v[212:215], v12 offset:0
ds_read_b128 v[216:219], v12 offset:4096
v_mfma_f32_32x32x16_bf16 v[96:111], v[36:39], v[48:51], v[96:111]
ds_read_b64_tr_b16 v[204:205], v8 offset:12288
ds_read_b64_tr_b16 v[206:207], v8 offset:13056
ds_read_b64_tr_b16 v[208:209], v9 offset:12288
ds_read_b64_tr_b16 v[210:211], v9 offset:13056
v_mfma_f32_32x32x16_bf16 v[112:127], v[36:39], v[52:55], v[112:127]
ds_read_b64_tr_b16 v[16:17], v7 offset:15360
ds_read_b64_tr_b16 v[18:19], v7 offset:16128
ds_read_b128 v[28:31], v13 offset:0
s_mov_b32 s36, s52
s_add_u32 s52, s52, 98304
s_cmp_ge_u32 s52, 1966080
s_cselect_b32 s52, 0, s52
s_add_u32 m0, s34, 0
s_nop 0
buffer_load_dwordx4 v4, s[12:15], s36 offen lds
v_mfma_f32_32x32x16_bf16 v[128:143], v[40:43], v[48:51], v[128:143]
ds_read_b128 v[32:35], v13 offset:4096
ds_read_b64_tr_b16 v[20:21], v8 offset:15360
ds_read_b64_tr_b16 v[22:23], v8 offset:16128
s_add_u32 m0, s34, 1024
s_nop 0
buffer_load_dwordx4 v5, s[12:15], s36 offen lds
v_mfma_f32_32x32x16_bf16 v[144:159], v[40:43], v[52:55], v[144:159]
ds_read_b64_tr_b16 v[24:25], v9 offset:15360
ds_read_b64_tr_b16 v[26:27], v9 offset:16128
v_mfma_f32_32x32x16_bf16 v[160:175], v[44:47], v[48:51], v[160:175]
s_add_u32 m0, s34, 2048
s_nop 0
buffer_load_dwordx4 v6, s[12:15], s36 offen lds
v_mfma_f32_32x32x16_bf16 v[176:191], v[44:47], v[52:55], v[176:191]
s_waitcnt lgkmcnt(13)
v_mfma_f32_32x32x16_bf16 v[96:111], v[200:203], v[212:215], v[96:111]
s_waitcnt lgkmcnt(12)
v_mfma_f32_32x32x16_bf16 v[112:127], v[200:203], v[216:219], v[112:127]
s_waitcnt lgkmcnt(10)
v_mfma_f32_32x32x16_bf16 v[128:143], v[204:207], v[212:215], v[128:143]
v_mfma_f32_32x32x16_bf16 v[144:159], v[204:207], v[216:219], v[144:159]
s_waitcnt lgkmcnt(8)
v_mfma_f32_32x32x16_bf16 v[160:175], v[208:211], v[212:215], v[160:175]
v_mfma_f32_32x32x16_bf16 v[176:191], v[208:211], v[216:219], v[176:191]
s_waitcnt lgkmcnt(0)
s_waitcnt vmcnt(6)
s_barrier
ds_read_b64_tr_b16 v[36:37], v7 offset:24576
ds_read_b64_tr_b16 v[38:39], v7 offset:25344
ds_read_b128 v[48:51], v10 offset:16384
ds_read_b128 v[52:55], v10 offset:20480
v_mfma_f32_32x32x16_bf16 v[96:111], v[16:19], v[28:31], v[96:111]
ds_read_b64_tr_b16 v[40:41], v8 offset:24576
ds_read_b64_tr_b16 v[42:43], v8 offset:25344
ds_read_b64_tr_b16 v[44:45], v9 offset:24576
ds_read_b64_tr_b16 v[46:47], v9 offset:25344
v_mfma_f32_32x32x16_bf16 v[112:127], v[16:19], v[32:35], v[112:127]
ds_read_b64_tr_b16 v[200:201], v7 offset:27648
ds_read_b64_tr_b16 v[202:203], v7 offset:28416
ds_read_b128 v[212:215], v11 offset:16384
s_mov_b32 s37, s53
s_add_u32 s53, s53, 128
s_cmp_ge_u32 s53, 1280
s_cselect_b32 s53, 0, s53
s_add_u32 m0, s35, 0
s_nop 0
buffer_load_dwordx4 v2, s[8:11], s37 offen lds
s_add_u32 m0, s35, 1024
s_nop 0
buffer_load_dwordx4 v3, s[8:11], s37 offen lds
v_mfma_f32_32x32x16_bf16 v[128:143], v[20:23], v[28:31], v[128:143]
ds_read_b128 v[216:219], v11 offset:20480
ds_read_b64_tr_b16 v[204:205], v8 offset:27648
ds_read_b64_tr_b16 v[206:207], v8 offset:28416
s_add_u32 s37, s37, 20480
s_add_u32 m0, s35, 2048
s_nop 0
buffer_load_dwordx4 v2, s[8:11], s37 offen lds
v_mfma_f32_32x32x16_bf16 v[144:159], v[20:23], v[32:35], v[144:159]
ds_read_b64_tr_b16 v[208:209], v9 offset:27648
ds_read_b64_tr_b16 v[210:211], v9 offset:28416
s_add_u32 m0, s35, 3072
s_nop 0
buffer_load_dwordx4 v3, s[8:11], s37 offen lds
s_mov_b32 s36, s52
s_add_u32 s52, s52, 98304
s_cmp_ge_u32 s52, 1966080
s_cselect_b32 s52, 0, s52
s_add_u32 m0, s34, 12288
s_nop 0
buffer_load_dwordx4 v4, s[12:15], s36 offen lds
v_mfma_f32_32x32x16_bf16 v[160:175], v[24:27], v[28:31], v[160:175]
s_add_u32 m0, s34, 13312
s_nop 0
buffer_load_dwordx4 v5, s[12:15], s36 offen lds
v_mfma_f32_32x32x16_bf16 v[176:191], v[24:27], v[32:35], v[176:191]
s_add_u32 m0, s34, 14336
s_nop 0
buffer_load_dwordx4 v6, s[12:15], s36 offen lds
s_waitcnt lgkmcnt(13)
v_mfma_f32_32x32x16_bf16 v[96:111], v[36:39], v[48:51], v[96:111]
s_waitcnt lgkmcnt(12)
v_mfma_f32_32x32x16_bf16 v[112:127], v[36:39], v[52:55], v[112:127]
s_waitcnt lgkmcnt(10)
v_mfma_f32_32x32x16_bf16 v[128:143], v[40:43], v[48:51], v[128:143]
v_mfma_f32_32x32x16_bf16 v[144:159], v[40:43], v[52:55], v[144:159]
s_waitcnt lgkmcnt(8)
v_mfma_f32_32x32x16_bf16 v[160:175], v[44:47], v[48:51], v[160:175]
v_mfma_f32_32x32x16_bf16 v[176:191], v[44:47], v[52:55], v[176:191]
s_waitcnt lgkmcnt(0)
s_waitcnt vmcnt(10)
s_barrier
ds_read_b64_tr_b16 v[16:17], v7 offset:36864
ds_read_b64_tr_b16 v[18:19], v7 offset:37632
ds_read_b128 v[28:31], v12 offset:16384
ds_read_b128 v[32:35], v12 offset:20480
v_mfma_f32_32x32x16_bf16 v[96:111], v[200:203], v[212:215], v[96:111]
ds_read_b64_tr_b16 v[20:21], v8 offset:36864
ds_read_b64_tr_b16 v[22:23], v8 offset:37632
ds_read_b64_tr_b16 v[24:25], v9 offset:36864
ds_read_b64_tr_b16 v[26:27], v9 offset:37632
v_mfma_f32_32x32x16_bf16 v[112:127], v[200:203], v[216:219], v[112:127]
ds_read_b64_tr_b16 v[36:37], v7 offset:39936
ds_read_b64_tr_b16 v[38:39], v7 offset:40704
ds_read_b128 v[48:51], v13 offset:16384
s_mov_b32 s36, s52
s_add_u32 s52, s52, 98304
s_cmp_ge_u32 s52, 1966080
s_cselect_b32 s52, 0, s52
s_add_u32 m0, s34, 24576
s_nop 0
buffer_load_dwordx4 v4, s[12:15], s36 offen lds
v_mfma_f32_32x32x16_bf16 v[128:143], v[204:207], v[212:215], v[128:143]
ds_read_b128 v[52:55], v13 offset:20480
ds_read_b64_tr_b16 v[40:41], v8 offset:39936
ds_read_b64_tr_b16 v[42:43], v8 offset:40704
s_add_u32 m0, s34, 25600
s_nop 0
buffer_load_dwordx4 v5, s[12:15], s36 offen lds
v_mfma_f32_32x32x16_bf16 v[144:159], v[204:207], v[216:219], v[144:159]
ds_read_b64_tr_b16 v[44:45], v9 offset:39936
ds_read_b64_tr_b16 v[46:47], v9 offset:40704
v_mfma_f32_32x32x16_bf16 v[160:175], v[208:211], v[212:215], v[160:175]
s_add_u32 m0, s34, 26624
s_nop 0
buffer_load_dwordx4 v6, s[12:15], s36 offen lds
v_mfma_f32_32x32x16_bf16 v[176:191], v[208:211], v[216:219], v[176:191]
s_waitcnt lgkmcnt(13)
v_mfma_f32_32x32x16_bf16 v[96:111], v[16:19], v[28:31], v[96:111]
s_waitcnt lgkmcnt(12)
v_mfma_f32_32x32x16_bf16 v[112:127], v[16:19], v[32:35], v[112:127]
s_waitcnt lgkmcnt(10)
v_mfma_f32_32x32x16_bf16 v[128:143], v[20:23], v[28:31], v[128:143]
v_mfma_f32_32x32x16_bf16 v[144:159], v[20:23], v[32:35], v[144:159]
s_waitcnt lgkmcnt(8)
v_mfma_f32_32x32x16_bf16 v[160:175], v[24:27], v[28:31], v[160:175]
v_mfma_f32_32x32x16_bf16 v[176:191], v[24:27], v[32:35], v[176:191]
s_waitcnt lgkmcnt(0)
s_waitcnt vmcnt(6)
s_barrier
ds_read_b64_tr_b16 v[200:201], v7 offset:0
ds_read_b64_tr_b16 v[202:203], v7 offset:768
ds_read_b128 v[212:215], v10 offset:0
ds_read_b128 v[216:219], v10 offset:4096
v_mfma_f32_32x32x16_bf16 v[96:111], v[36:39], v[48:51], v[96:111]
ds_read_b64_tr_b16 v[204:205], v8 offset:0
ds_read_b64_tr_b16 v[206:207], v8 offset:768
ds_read_b64_tr_b16 v[208:209], v9 offset:0
ds_read_b64_tr_b16 v[210:211], v9 offset:768
v_mfma_f32_32x32x16_bf16 v[112:127], v[36:39], v[52:55], v[112:127]
ds_read_b64_tr_b16 v[16:17], v7 offset:3072
ds_read_b64_tr_b16 v[18:19], v7 offset:3840
ds_read_b128 v[28:31], v11 offset:0
s_mov_b32 s37, s53
s_add_u32 s53, s53, 128
s_cmp_ge_u32 s53, 1280
s_cselect_b32 s53, 0, s53
s_add_u32 m0, s35, 16384
s_nop 0
buffer_load_dwordx4 v2, s[8:11], s37 offen lds
s_add_u32 m0, s35, 17408
s_nop 0
buffer_load_dwordx4 v3, s[8:11], s37 offen lds
v_mfma_f32_32x32x16_bf16 v[128:143], v[40:43], v[48:51], v[128:143]
ds_read_b128 v[32:35], v11 offset:4096
ds_read_b64_tr_b16 v[20:21], v8 offset:3072
ds_read_b64_tr_b16 v[22:23], v8 offset:3840
s_add_u32 s37, s37, 20480
s_add_u32 m0, s35, 18432
s_nop 0
buffer_load_dwordx4 v2, s[8:11], s37 offen lds
v_mfma_f32_32x32x16_bf16 v[144:159], v[40:43], v[52:55], v[144:159]
ds_read_b64_tr_b16 v[24:25], v9 offset:3072
ds_read_b64_tr_b16 v[26:27], v9 offset:3840
s_add_u32 m0, s35, 19456
s_nop 0
buffer_load_dwordx4 v3, s[8:11], s37 offen lds
s_mov_b32 s36, s52
s_add_u32 s52, s52, 98304
s_cmp_ge_u32 s52, 1966080
s_cselect_b32 s52, 0, s52
s_add_u32 m0, s34, 36864
s_nop 0
buffer_load_dwordx4 v4, s[12:15], s36 offen lds
v_mfma_f32_32x32x16_bf16 v[160:175], v[44:47], v[48:51], v[160:175]
s_add_u32 m0, s34, 37888
s_nop 0
buffer_load_dwordx4 v5, s[12:15], s36 offen lds
v_mfma_f32_32x32x16_bf16 v[176:191], v[44:47], v[52:55], v[176:191]
s_add_u32 m0, s34, 38912
s_nop 0
buffer_load_dwordx4 v6, s[12:15], s36 offen lds
s_waitcnt lgkmcnt(13)
v_mfma_f32_32x32x16_bf16 v[96:111], v[200:203], v[212:215], v[96:111]
s_waitcnt lgkmcnt(12)
v_mfma_f32_32x32x16_bf16 v[112:127], v[200:203], v[216:219], v[112:127]
s_waitcnt lgkmcnt(10)
v_mfma_f32_32x32x16_bf16 v[128:143], v[204:207], v[212:215], v[128:143]
v_mfma_f32_32x32x16_bf16 v[144:159], v[204:207], v[216:219], v[144:159]
s_waitcnt lgkmcnt(8)
v_mfma_f32_32x32x16_bf16 v[160:175], v[208:211], v[212:215], v[160:175]
v_mfma_f32_32x32x16_bf16 v[176:191], v[208:211], v[216:219], v[176:191]
s_waitcnt lgkmcnt(0)
s_waitcnt vmcnt(10)
s_barrier
ds_read_b64_tr_b16 v[36:37], v7 offset:12288
ds_read_b64_tr_b16 v[38:39], v7 offset:13056
ds_read_b128 v[48:51], v12 offset:0
ds_read_b128 v[52:55], v12 offset:4096
v_mfma_f32_32x32x16_bf16 v[96:111], v[16:19], v[28:31], v[96:111]
ds_read_b64_tr_b16 v[40:41], v8 offset:12288
ds_read_b64_tr_b16 v[42:43], v8 offset:13056
ds_read_b64_tr_b16 v[44:45], v9 offset:12288
ds_read_b64_tr_b16 v[46:47], v9 offset:13056
v_mfma_f32_32x32x16_bf16 v[112:127], v[16:19], v[32:35], v[112:127]
ds_read_b64_tr_b16 v[200:201], v7 offset:15360
ds_read_b64_tr_b16 v[202:203], v7 offset:16128
ds_read_b128 v[212:215], v13 offset:0
s_mov_b32 s36, s52
s_add_u32 s52, s52, 98304
s_cmp_ge_u32 s52, 1966080
s_cselect_b32 s52, 0, s52
s_add_u32 m0, s34, 0
s_nop 0
buffer_load_dwordx4 v4, s[12:15], s36 offen lds
v_mfma_f32_32x32x16_bf16 v[128:143], v[20:23], v[28:31], v[128:143]
ds_read_b128 v[216:219], v13 offset:4096
ds_read_b64_tr_b16 v[204:205], v8 offset:15360
ds_read_b64_tr_b16 v[206:207], v8 offset:16128
s_add_u32 m0, s34, 1024
s_nop 0
buffer_load_dwordx4 v5, s[12:15], s36 offen lds
v_mfma_f32_32x32x16_bf16 v[144:159], v[20:23], v[32:35], v[144:159]
ds_read_b64_tr_b16 v[208:209], v9 offset:15360
ds_read_b64_tr_b16 v[210:211], v9 offset:16128
v_mfma_f32_32x32x16_bf16 v[160:175], v[24:27], v[28:31], v[160:175]
s_add_u32 m0, s34, 2048
s_nop 0
buffer_load_dwordx4 v6, s[12:15], s36 offen lds
v_mfma_f32_32x32x16_bf16 v[176:191], v[24:27], v[32:35], v[176:191]
s_waitcnt lgkmcnt(13)
v_mfma_f32_32x32x16_bf16 v[96:111], v[36:39], v[48:51], v[96:111]
s_waitcnt lgkmcnt(12)
v_mfma_f32_32x32x16_bf16 v[112:127], v[36:39], v[52:55], v[112:127]
s_waitcnt lgkmcnt(10)
v_mfma_f32_32x32x16_bf16 v[128:143], v[40:43], v[48:51], v[128:143]
v_mfma_f32_32x32x16_bf16 v[144:159], v[40:43], v[52:55], v[144:159]
s_waitcnt lgkmcnt(8)
v_mfma_f32_32x32x16_bf16 v[160:175], v[44:47], v[48:51], v[160:175]
v_mfma_f32_32x32x16_bf16 v[176:191], v[44:47], v[52:55], v[176:191]
s_waitcnt lgkmcnt(0)
s_waitcnt vmcnt(6)
s_barrier
ds_read_b64_tr_b16 v[16:17], v7 offset:24576
ds_read_b64_tr_b16 v[18:19], v7 offset:25344
ds_read_b128 v[28:31], v10 offset:16384
ds_read_b128 v[32:35], v10 offset:20480
v_mfma_f32_32x32x16_bf16 v[96:111], v[200:203], v[212:215], v[96:111]
ds_read_b64_tr_b16 v[20:21], v8 offset:24576
ds_read_b64_tr_b16 v[22:23], v8 offset:25344
ds_read_b64_tr_b16 v[24:25], v9 offset:24576
ds_read_b64_tr_b16 v[26:27], v9 offset:25344
v_mfma_f32_32x32x16_bf16 v[112:127], v[200:203], v[216:219], v[112:127]
ds_read_b64_tr_b16 v[36:37], v7 offset:27648
ds_read_b64_tr_b16 v[38:39], v7 offset:28416
ds_read_b128 v[48:51], v11 offset:16384
s_mov_b32 s37, s53
s_add_u32 s53, s53, 128
s_cmp_ge_u32 s53, 1280
s_cselect_b32 s53, 0, s53
s_add_u32 m0, s35, 0
s_nop 0
buffer_load_dwordx4 v2, s[8:11], s37 offen lds
s_add_u32 m0, s35, 1024
s_nop 0
buffer_load_dwordx4 v3, s[8:11], s37 offen lds
v_mfma_f32_32x32x16_bf16 v[128:143], v[204:207], v[212:215], v[128:143]
ds_read_b128 v[52:55], v11 offset:20480
ds_read_b64_tr_b16 v[40:41], v8 offset:27648
ds_read_b64_tr_b16 v[42:43], v8 offset:28416
s_add_u32 s37, s37, 20480
s_add_u32 m0, s35, 2048
s_nop 0
buffer_load_dwordx4 v2, s[8:11], s37 offen lds
v_mfma_f32_32x32x16_bf16 v[144:159], v[204:207], v[216:219], v[144:159]
ds_read_b64_tr_b16 v[44:45], v9 offset:27648
ds_read_b64_tr_b16 v[46:47], v9 offset:28416
s_add_u32 m0, s35, 3072
s_nop 0
buffer_load_dwordx4 v3, s[8:11], s37 offen lds
s_mov_b32 s36, s52
s_add_u32 s52, s52, 98304
s_cmp_ge_u32 s52, 1966080
s_cselect_b32 s52, 0, s52
s_add_u32 m0, s34, 12288
s_nop 0
buffer_load_dwordx4 v4, s[12:15], s36 offen lds
v_mfma_f32_32x32x16_bf16 v[160:175], v[208:211], v[212:215], v[160:175]
s_add_u32 m0, s34, 13312
s_nop 0
buffer_load_dwordx4 v5, s[12:15], s36 offen lds
v_mfma_f32_32x32x16_bf16 v[176:191], v[208:211], v[216:219], v[176:191]
s_add_u32 m0, s34, 14336
s_nop 0
buffer_load_dwordx4 v6, s[12:15], s36 offen lds
s_waitcnt lgkmcnt(13)
v_mfma_f32_32x32x16_bf16 v[96:111], v[16:19], v[28:31], v[96:111]
s_waitcnt lgkmcnt(12)
v_mfma_f32_32x32x16_bf16 v[112:127], v[16:19], v[32:35], v[112:127]
s_waitcnt lgkmcnt(10)
v_mfma_f32_32x32x16_bf16 v[128:143], v[20:23], v[28:31], v[128:143]
v_mfma_f32_32x32x16_bf16 v[144:159], v[20:23], v[32:35], v[144:159]
s_waitcnt lgkmcnt(8)
v_mfma_f32_32x32x16_bf16 v[160:175], v[24:27], v[28:31], v[160:175]
v_mfma_f32_32x32x16_bf16 v[176:191], v[24:27], v[32:35], v[176:191]
s_waitcnt lgkmcnt(0)
s_waitcnt vmcnt(10)
s_barrier
ds_read_b64_tr_b16 v[200:201], v7 offset:36864
ds_read_b64_tr_b16 v[202:203], v7 offset:37632
ds_read_b128 v[212:215], v12 offset:16384
ds_read_b128 v[216:219], v12 offset:20480
v_mfma_f32_32x32x16_bf16 v[96:111], v[36:39], v[48:51], v[96:111]
ds_read_b64_tr_b16 v[204:205], v8 offset:36864
ds_read_b64_tr_b16 v[206:207], v8 offset:37632
ds_read_b64_tr_b16 v[208:209], v9 offset:36864
ds_read_b64_tr_b16 v[210:211], v9 offset:37632
v_mfma_f32_32x32x16_bf16 v[112:127], v[36:39], v[52:55], v[112:127]
ds_read_b64_tr_b16 v[16:17], v7 offset:39936
ds_read_b64_tr_b16 v[18:19], v7 offset:40704
ds_read_b128 v[28:31], v13 offset:16384
s_mov_b32 s36, s52
s_add_u32 s52, s52, 98304
s_cmp_ge_u32 s52, 1966080
s_cselect_b32 s52, 0, s52
s_add_u32 m0, s34, 24576
s_nop 0
buffer_load_dwordx4 v4, s[12:15], s36 offen lds
v_mfma_f32_32x32x16_bf16 v[128:143], v[40:43], v[48:51], v[128:143]
ds_read_b128 v[32:35], v13 offset:20480
ds_read_b64_tr_b16 v[20:21], v8 offset:39936
ds_read_b64_tr_b16 v[22:23], v8 offset:40704
s_add_u32 m0, s34, 25600
s_nop 0
buffer_load_dwordx4 v5, s[12:15], s36 offen lds
v_mfma_f32_32x32x16_bf16 v[144:159], v[40:43], v[52:55], v[144:159]
ds_read_b64_tr_b16 v[24:25], v9 offset:39936
ds_read_b64_tr_b16 v[26:27], v9 offset:40704
v_mfma_f32_32x32x16_bf16 v[160:175], v[44:47], v[48:51], v[160:175]
s_add_u32 m0, s34, 26624
s_nop 0
buffer_load_dwordx4 v6, s[12:15], s36 offen lds
v_mfma_f32_32x32x16_bf16 v[176:191], v[44:47], v[52:55], v[176:191]
s_waitcnt lgkmcnt(13)
v_mfma_f32_32x32x16_bf16 v[96:111], v[200:203], v[212:215], v[96:111]
s_waitcnt lgkmcnt(12)
v_mfma_f32_32x32x16_bf16 v[112:127], v[200:203], v[216:219], v[112:127]
s_waitcnt lgkmcnt(10)
v_mfma_f32_32x32x16_bf16 v[128:143], v[204:207], v[212:215], v[128:143]
v_mfma_f32_32x32x16_bf16 v[144:159], v[204:207], v[216:219], v[144:159]
s_waitcnt lgkmcnt(8)
v_mfma_f32_32x32x16_bf16 v[160:175], v[208:211], v[212:215], v[160:175]
v_mfma_f32_32x32x16_bf16 v[176:191], v[208:211], v[216:219], v[176:191]
s_waitcnt lgkmcnt(0)
s_waitcnt vmcnt(6)
s_barrier
ds_read_b64_tr_b16 v[36:37], v7 offset:0
ds_read_b64_tr_b16 v[38:39], v7 offset:768
ds_read_b128 v[48:51], v10 offset:0
ds_read_b128 v[52:55], v10 offset:4096
v_mfma_f32_32x32x16_bf16 v[96:111], v[16:19], v[28:31], v[96:111]
ds_read_b64_tr_b16 v[40:41], v8 offset:0
ds_read_b64_tr_b16 v[42:43], v8 offset:768
ds_read_b64_tr_b16 v[44:45], v9 offset:0
ds_read_b64_tr_b16 v[46:47], v9 offset:768
v_mfma_f32_32x32x16_bf16 v[112:127], v[16:19], v[32:35], v[112:127]
ds_read_b64_tr_b16 v[200:201], v7 offset:3072
ds_read_b64_tr_b16 v[202:203], v7 offset:3840
ds_read_b128 v[212:215], v11 offset:0
s_mov_b32 s37, s53
s_add_u32 s53, s53, 128
s_cmp_ge_u32 s53, 1280
s_cselect_b32 s53, 0, s53
s_add_u32 m0, s35, 16384
s_nop 0
buffer_load_dwordx4 v2, s[8:11], s37 offen lds
s_add_u32 m0, s35, 17408
s_nop 0
buffer_load_dwordx4 v3, s[8:11], s37 offen lds
v_mfma_f32_32x32x16_bf16 v[128:143], v[20:23], v[28:31], v[128:143]
ds_read_b128 v[216:219], v11 offset:4096
ds_read_b64_tr_b16 v[204:205], v8 offset:3072
ds_read_b64_tr_b16 v[206:207], v8 offset:3840
s_add_u32 s37, s37, 20480
s_add_u32 m0, s35, 18432
s_nop 0
buffer_load_dwordx4 v2, s[8:11], s37 offen lds
v_mfma_f32_32x32x16_bf16 v[144:159], v[20:23], v[32:35], v[144:159]
ds_read_b64_tr_b16 v[208:209], v9 offset:3072
ds_read_b64_tr_b16 v[210:211], v9 offset:3840
s_add_u32 m0, s35, 19456
s_nop 0
buffer_load_dwordx4 v3, s[8:11], s37 offen lds
s_mov_b32 s36, s52
s_add_u32 s52, s52, 98304
s_cmp_ge_u32 s52, 1966080
s_cselect_b32 s52, 0, s52
s_add_u32 m0, s34, 36864
s_nop 0
buffer_load_dwordx4 v4, s[12:15], s36 offen lds
v_mfma_f32_32x32x16_bf16 v[160:175], v[24:27], v[28:31], v[160:175]
s_add_u32 m0, s34, 37888
s_nop 0
buffer_load_dwordx4 v5, s[12:15], s36 offen lds
v_mfma_f32_32x32x16_bf16 v[176:191], v[24:27], v[32:35], v[176:191]
s_add_u32 m0, s34, 38912
s_nop 0
buffer_load_dwordx4 v6, s[12:15], s36 offen lds
s_waitcnt lgkmcnt(13)
v_mfma_f32_32x32x16_bf16 v[96:111], v[36:39], v[48:51], v[96:111]
s_waitcnt lgkmcnt(12)
v_mfma_f32_32x32x16_bf16 v[112:127], v[36:39], v[52:55], v[112:127]
s_waitcnt lgkmcnt(10)
v_mfma_f32_32x32x16_bf16 v[128:143], v[40:43], v[48:51], v[128:143]
v_mfma_f32_32x32x16_bf16 v[144:159], v[40:43], v[52:55], v[144:159]
s_waitcnt lgkmcnt(8)
v_mfma_f32_32x32x16_bf16 v[160:175], v[44:47], v[48:51], v[160:175]
v_mfma_f32_32x32x16_bf16 v[176:191], v[44:47], v[52:55], v[176:191]
s_waitcnt lgkmcnt(0)
s_waitcnt vmcnt(10)
s_barrier
ds_read_b64_tr_b16 v[16:17], v7 offset:12288
ds_read_b64_tr_b16 v[18:19], v7 offset:13056
ds_read_b128 v[28:31], v12 offset:0
ds_read_b128 v[32:35], v12 offset:4096
v_mfma_f32_32x32x16_bf16 v[96:111], v[200:203], v[212:215], v[96:111]
ds_read_b64_tr_b16 v[20:21], v8 offset:12288
ds_read_b64_tr_b16 v[22:23], v8 offset:13056
ds_read_b64_tr_b16 v[24:25], v9 offset:12288
ds_read_b64_tr_b16 v[26:27], v9 offset:13056
v_mfma_f32_32x32x16_bf16 v[112:127], v[200:203], v[216:219], v[112:127]
ds_read_b64_tr_b16 v[36:37], v7 offset:15360
ds_read_b64_tr_b16 v[38:39], v7 offset:16128
ds_read_b128 v[48:51], v13 offset:0
s_mov_b32 s36, s52
s_add_u32 s52, s52, 98304
s_cmp_ge_u32 s52, 1966080
s_cselect_b32 s52, 0, s52
s_add_u32 m0, s34, 0
s_nop 0
buffer_load_dwordx4 v4, s[12:15], s36 offen lds
v_mfma_f32_32x32x16_bf16 v[128:143], v[204:207], v[212:215], v[128:143]
ds_read_b128 v[52:55], v13 offset:4096
ds_read_b64_tr_b16 v[40:41], v8 offset:15360
ds_read_b64_tr_b16 v[42:43], v8 offset:16128
s_add_u32 m0, s34, 1024
s_nop 0
buffer_load_dwordx4 v5, s[12:15], s36 offen lds
v_mfma_f32_32x32x16_bf16 v[144:159], v[204:207], v[216:219], v[144:159]
ds_read_b64_tr_b16 v[44:45], v9 offset:15360
ds_read_b64_tr_b16 v[46:47], v9 offset:16128
v_mfma_f32_32x32x16_bf16 v[160:175], v[208:211], v[212:215], v[160:175]
s_add_u32 m0, s34, 2048
s_nop 0
buffer_load_dwordx4 v6, s[12:15], s36 offen lds
v_mfma_f32_32x32x16_bf16 v[176:191], v[208:211], v[216:219], v[176:191]
s_waitcnt lgkmcnt(13)
v_mfma_f32_32x32x16_bf16 v[96:111], v[16:19], v[28:31], v[96:111]
s_waitcnt lgkmcnt(12)
v_mfma_f32_32x32x16_bf16 v[112:127], v[16:19], v[32:35], v[112:127]
s_waitcnt lgkmcnt(10)
v_mfma_f32_32x32x16_bf16 v[128:143], v[20:23], v[28:31], v[128:143]
v_mfma_f32_32x32x16_bf16 v[144:159], v[20:23], v[32:35], v[144:159]
s_waitcnt lgkmcnt(8)
v_mfma_f32_32x32x16_bf16 v[160:175], v[24:27], v[28:31], v[160:175]
v_mfma_f32_32x32x16_bf16 v[176:191], v[24:27], v[32:35], v[176:191]
s_waitcnt lgkmcnt(0)
s_waitcnt vmcnt(6)
s_barrier
ds_read_b64_tr_b16 v[200:201], v7 offset:24576
ds_read_b64_tr_b16 v[202:203], v7 offset:25344
ds_read_b128 v[212:215], v10 offset:16384
ds_read_b128 v[216:219], v10 offset:20480
v_mfma_f32_32x32x16_bf16 v[96:111], v[36:39], v[48:51], v[96:111]
ds_read_b64_tr_b16 v[204:205], v8 offset:24576
ds_read_b64_tr_b16 v[206:207], v8 offset:25344
ds_read_b64_tr_b16 v[208:209], v9 offset:24576
ds_read_b64_tr_b16 v[210:211], v9 offset:25344
v_mfma_f32_32x32x16_bf16 v[112:127], v[36:39], v[52:55], v[112:127]
ds_read_b64_tr_b16 v[16:17], v7 offset:27648
ds_read_b64_tr_b16 v[18:19], v7 offset:28416
ds_read_b128 v[28:31], v11 offset:16384
s_mov_b32 s37, s53
s_add_u32 s53, s53, 128
s_cmp_ge_u32 s53, 1280
s_cselect_b32 s53, 0, s53
s_add_u32 m0, s35, 0
s_nop 0
buffer_load_dwordx4 v2, s[8:11], s37 offen lds
s_add_u32 m0, s35, 1024
s_nop 0
buffer_load_dwordx4 v3, s[8:11], s37 offen lds
v_mfma_f32_32x32x16_bf16 v[128:143], v[40:43], v[48:51], v[128:143]
ds_read_b128 v[32:35], v11 offset:20480
ds_read_b64_tr_b16 v[20:21], v8 offset:27648
ds_read_b64_tr_b16 v[22:23], v8 offset:28416
s_add_u32 s37, s37, 20480
s_add_u32 m0, s35, 2048
s_nop 0
buffer_load_dwordx4 v2, s[8:11], s37 offen lds
v_mfma_f32_32x32x16_bf16 v[144:159], v[40:43], v[52:55], v[144:159]
ds_read_b64_tr_b16 v[24:25], v9 offset:27648
ds_read_b64_tr_b16 v[26:27], v9 offset:28416
s_add_u32 m0, s35, 3072
s_nop 0
buffer_load_dwordx4 v3, s[8:11], s37 offen lds
s_mov_b32 s36, s52
s_add_u32 s52, s52, 98304
s_cmp_ge_u32 s52, 1966080
s_cselect_b32 s52, 0, s52
s_add_u32 m0, s34, 12288
s_nop 0
buffer_load_dwordx4 v4, s[12:15], s36 offen lds
v_mfma_f32_32x32x16_bf16 v[160:175], v[44:47], v[48:51], v[160:175]
s_add_u32 m0, s34, 13312
s_nop 0
buffer_load_dwordx4 v5, s[12:15], s36 offen lds
v_mfma_f32_32x32x16_bf16 v[176:191], v[44:47], v[52:55], v[176:191]
s_add_u32 m0, s34, 14336
s_nop 0
buffer_load_dwordx4 v6, s[12:15], s36 offen lds
s_waitcnt lgkmcnt(13)
v_mfma_f32_32x32x16_bf16 v[96:111], v[200:203], v[212:215], v[96:111]
s_waitcnt lgkmcnt(12)
v_mfma_f32_32x32x16_bf16 v[112:127], v[200:203], v[216:219], v[112:127]
s_waitcnt lgkmcnt(10)
v_mfma_f32_32x32x16_bf16 v[128:143], v[204:207], v[212:215], v[128:143]
v_mfma_f32_32x32x16_bf16 v[144:159], v[204:207], v[216:219], v[144:159]
s_waitcnt lgkmcnt(8)
v_mfma_f32_32x32x16_bf16 v[160:175], v[208:211], v[212:215], v[160:175]
v_mfma_f32_32x32x16_bf16 v[176:191], v[208:211], v[216:219], v[176:191]
s_waitcnt lgkmcnt(0)
s_waitcnt vmcnt(10)
s_barrier
ds_read_b64_tr_b16 v[36:37], v7 offset:36864
ds_read_b64_tr_b16 v[38:39], v7 offset:37632
ds_read_b128 v[48:51], v12 offset:16384
ds_read_b128 v[52:55], v12 offset:20480
v_mfma_f32_32x32x16_bf16 v[96:111], v[16:19], v[28:31], v[96:111]
ds_read_b64_tr_b16 v[40:41], v8 offset:36864
ds_read_b64_tr_b16 v[42:43], v8 offset:37632
ds_read_b64_tr_b16 v[44:45], v9 offset:36864
ds_read_b64_tr_b16 v[46:47], v9 offset:37632
v_mfma_f32_32x32x16_bf16 v[112:127], v[16:19], v[32:35], v[112:127]
ds_read_b64_tr_b16 v[200:201], v7 offset:39936
ds_read_b64_tr_b16 v[202:203], v7 offset:40704
ds_read_b128 v[212:215], v13 offset:16384
s_mov_b32 s36, s52
s_add_u32 s52, s52, 98304
s_cmp_ge_u32 s52, 1966080
s_cselect_b32 s52, 0, s52
s_add_u32 m0, s34, 24576
s_nop 0
buffer_load_dwordx4 v4, s[12:15], s36 offen lds
v_mfma_f32_32x32x16_bf16 v[128:143], v[20:23], v[28:31], v[128:143]
ds_read_b128 v[216:219], v13 offset:20480
ds_read_b64_tr_b16 v[204:205], v8 offset:39936
ds_read_b64_tr_b16 v[206:207], v8 offset:40704
s_add_u32 m0, s34, 25600
s_nop 0
buffer_load_dwordx4 v5, s[12:15], s36 offen lds
v_mfma_f32_32x32x16_bf16 v[144:159], v[20:23], v[32:35], v[144:159]
ds_read_b64_tr_b16 v[208:209], v9 offset:39936
ds_read_b64_tr_b16 v[210:211], v9 offset:40704
v_mfma_f32_32x32x16_bf16 v[160:175], v[24:27], v[28:31], v[160:175]
s_add_u32 m0, s34, 26624
s_nop 0
buffer_load_dwordx4 v6, s[12:15], s36 offen lds
v_mfma_f32_32x32x16_bf16 v[176:191], v[24:27], v[32:35], v[176:191]
s_waitcnt lgkmcnt(13)
v_mfma_f32_32x32x16_bf16 v[96:111], v[36:39], v[48:51], v[96:111]
s_waitcnt lgkmcnt(12)
v_mfma_f32_32x32x16_bf16 v[112:127], v[36:39], v[52:55], v[112:127]
s_waitcnt lgkmcnt(10)
v_mfma_f32_32x32x16_bf16 v[128:143], v[40:43], v[48:51], v[128:143]
v_mfma_f32_32x32x16_bf16 v[144:159], v[40:43], v[52:55], v[144:159]
s_waitcnt lgkmcnt(8)
v_mfma_f32_32x32x16_bf16 v[160:175], v[44:47], v[48:51], v[160:175]
v_mfma_f32_32x32x16_bf16 v[176:191], v[44:47], v[52:55], v[176:191]
s_waitcnt lgkmcnt(0)
s_waitcnt vmcnt(6)
s_barrier
ds_read_b64_tr_b16 v[16:17], v7 offset:0
ds_read_b64_tr_b16 v[18:19], v7 offset:768
ds_read_b128 v[28:31], v10 offset:0
ds_read_b128 v[32:35], v10 offset:4096
v_mfma_f32_32x32x16_bf16 v[96:111], v[200:203], v[212:215], v[96:111]
ds_read_b64_tr_b16 v[20:21], v8 offset:0
ds_read_b64_tr_b16 v[22:23], v8 offset:768
ds_read_b64_tr_b16 v[24:25], v9 offset:0
ds_read_b64_tr_b16 v[26:27], v9 offset:768
v_mfma_f32_32x32x16_bf16 v[112:127], v[200:203], v[216:219], v[112:127]
ds_read_b64_tr_b16 v[36:37], v7 offset:3072
ds_read_b64_tr_b16 v[38:39], v7 offset:3840
ds_read_b128 v[48:51], v11 offset:0
s_mov_b32 s37, s53
s_add_u32 s53, s53, 128
s_cmp_ge_u32 s53, 1280
s_cselect_b32 s53, 0, s53
s_add_u32 m0, s35, 16384
s_nop 0
buffer_load_dwordx4 v2, s[8:11], s37 offen lds
s_add_u32 m0, s35, 17408
s_nop 0
buffer_load_dwordx4 v3, s[8:11], s37 offen lds
v_mfma_f32_32x32x16_bf16 v[128:143], v[204:207], v[212:215], v[128:143]
ds_read_b128 v[52:55], v11 offset:4096
ds_read_b64_tr_b16 v[40:41], v8 offset:3072
ds_read_b64_tr_b16 v[42:43], v8 offset:3840
s_add_u32 s37, s37, 20480
s_add_u32 m0, s35, 18432
s_nop 0
buffer_load_dwordx4 v2, s[8:11], s37 offen lds
v_mfma_f32_32x32x16_bf16 v[144:159], v[204:207], v[216:219], v[144:159]
ds_read_b64_tr_b16 v[44:45], v9 offset:3072
ds_read_b64_tr_b16 v[46:47], v9 offset:3840
s_add_u32 m0, s35, 19456
s_nop 0
buffer_load_dwordx4 v3, s[8:11], s37 offen lds
s_mov_b32 s36, s52
s_add_u32 s52, s52, 98304
s_cmp_ge_u32 s52, 1966080
s_cselect_b32 s52, 0, s52
s_add_u32 m0, s34, 36864
s_nop 0
buffer_load_dwordx4 v4, s[12:15], s36 offen lds
v_mfma_f32_32x32x16_bf16 v[160:175], v[208:211], v[212:215], v[160:175]
s_add_u32 m0, s34, 37888
s_nop 0
buffer_load_dwordx4 v5, s[12:15], s36 offen lds
v_mfma_f32_32x32x16_bf16 v[176:191], v[208:211], v[216:219], v[176:191]
s_add_u32 m0, s34, 38912
s_nop 0
buffer_load_dwordx4 v6, s[12:15], s36 offen lds
s_waitcnt lgkmcnt(13)
v_mfma_f32_32x32x16_bf16 v[96:111], v[16:19], v[28:31], v[96:111]
s_waitcnt lgkmcnt(12)
v_mfma_f32_32x32x16_bf16 v[112:127], v[16:19], v[32:35], v[112:127]
s_waitcnt lgkmcnt(10)
v_mfma_f32_32x32x16_bf16 v[128:143], v[20:23], v[28:31], v[128:143]
v_mfma_f32_32x32x16_bf16 v[144:159], v[20:23], v[32:35], v[144:159]
s_waitcnt lgkmcnt(8)
v_mfma_f32_32x32x16_bf16 v[160:175], v[24:27], v[28:31], v[160:175]
v_mfma_f32_32x32x16_bf16 v[176:191], v[24:27], v[32:35], v[176:191]
s_waitcnt lgkmcnt(0)
s_waitcnt vmcnt(10)
s_barrier
ds_read_b64_tr_b16 v[200:201], v7 offset:12288
ds_read_b64_tr_b16 v[202:203], v7 offset:13056
ds_read_b128 v[212:215], v12 offset:0
ds_read_b128 v[216:219], v12 offset:4096
v_mfma_f32_32x32x16_bf16 v[96:111], v[36:39], v[48:51], v[96:111]
ds_read_b64_tr_b16 v[204:205], v8 offset:12288
ds_read_b64_tr_b16 v[206:207], v8 offset:13056
ds_read_b64_tr_b16 v[208:209], v9 offset:12288
ds_read_b64_tr_b16 v[210:211], v9 offset:13056
v_mfma_f32_32x32x16_bf16 v[112:127], v[36:39], v[52:55], v[112:127]
ds_read_b64_tr_b16 v[16:17], v7 offset:15360
ds_read_b64_tr_b16 v[18:19], v7 offset:16128
ds_read_b128 v[28:31], v13 offset:0
s_mov_b32 s36, s52
s_add_u32 s52, s52, 98304
s_cmp_ge_u32 s52, 1966080
s_cselect_b32 s52, 0, s52
s_add_u32 m0, s34, 0
s_nop 0
buffer_load_dwordx4 v4, s[12:15], s36 offen lds
v_mfma_f32_32x32x16_bf16 v[128:143], v[40:43], v[48:51], v[128:143]
ds_read_b128 v[32:35], v13 offset:4096
ds_read_b64_tr_b16 v[20:21], v8 offset:15360
ds_read_b64_tr_b16 v[22:23], v8 offset:16128
s_add_u32 m0, s34, 1024
s_nop 0
buffer_load_dwordx4 v5, s[12:15], s36 offen lds
v_mfma_f32_32x32x16_bf16 v[144:159], v[40:43], v[52:55], v[144:159]
ds_read_b64_tr_b16 v[24:25], v9 offset:15360
ds_read_b64_tr_b16 v[26:27], v9 offset:16128
v_mfma_f32_32x32x16_bf16 v[160:175], v[44:47], v[48:51], v[160:175]
s_add_u32 m0, s34, 2048
s_nop 0
buffer_load_dwordx4 v6, s[12:15], s36 offen lds
v_mfma_f32_32x32x16_bf16 v[176:191], v[44:47], v[52:55], v[176:191]
s_waitcnt lgkmcnt(13)
v_mfma_f32_32x32x16_bf16 v[96:111], v[200:203], v[212:215], v[96:111]
s_waitcnt lgkmcnt(12)
v_mfma_f32_32x32x16_bf16 v[112:127], v[200:203], v[216:219], v[112:127]
s_waitcnt lgkmcnt(10)
v_mfma_f32_32x32x16_bf16 v[128:143], v[204:207], v[212:215], v[128:143]
v_mfma_f32_32x32x16_bf16 v[144:159], v[204:207], v[216:219], v[144:159]
s_waitcnt lgkmcnt(8)
v_mfma_f32_32x32x16_bf16 v[160:175], v[208:211], v[212:215], v[160:175]
v_mfma_f32_32x32x16_bf16 v[176:191], v[208:211], v[216:219], v[176:191]
s_waitcnt lgkmcnt(0)
s_waitcnt vmcnt(6)
s_barrier
ds_read_b64_tr_b16 v[36:37], v7 offset:24576
ds_read_b64_tr_b16 v[38:39], v7 offset:25344
ds_read_b128 v[48:51], v10 offset:16384
ds_read_b128 v[52:55], v10 offset:20480
v_mfma_f32_32x32x16_bf16 v[96:111], v[16:19], v[28:31], v[96:111]
ds_read_b64_tr_b16 v[40:41], v8 offset:24576
ds_read_b64_tr_b16 v[42:43], v8 offset:25344
ds_read_b64_tr_b16 v[44:45], v9 offset:24576
ds_read_b64_tr_b16 v[46:47], v9 offset:25344
v_mfma_f32_32x32x16_bf16 v[112:127], v[16:19], v[32:35], v[112:127]
ds_read_b64_tr_b16 v[200:201], v7 offset:27648
ds_read_b64_tr_b16 v[202:203], v7 offset:28416
ds_read_b128 v[212:215], v11 offset:16384
s_mov_b32 s37, s53
s_add_u32 s53, s53, 128
s_cmp_ge_u32 s53, 1280
s_cselect_b32 s53, 0, s53
s_add_u32 m0, s35, 0
s_nop 0
buffer_load_dwordx4 v2, s[8:11], s37 offen lds
s_add_u32 m0, s35, 1024
s_nop 0
buffer_load_dwordx4 v3, s[8:11], s37 offen lds
v_mfma_f32_32x32x16_bf16 v[128:143], v[20:23], v[28:31], v[128:143]
ds_read_b128 v[216:219], v11 offset:20480
ds_read_b64_tr_b16 v[204:205], v8 offset:27648
ds_read_b64_tr_b16 v[206:207], v8 offset:28416
s_add_u32 s37, s37, 20480
s_add_u32 m0, s35, 2048
s_nop 0
buffer_load_dwordx4 v2, s[8:11], s37 offen lds
v_mfma_f32_32x32x16_bf16 v[144:159], v[20:23], v[32:35], v[144:159]
ds_read_b64_tr_b16 v[208:209], v9 offset:27648
ds_read_b64_tr_b16 v[210:211], v9 offset:28416
s_add_u32 m0, s35, 3072
s_nop 0
buffer_load_dwordx4 v3, s[8:11], s37 offen lds
s_mov_b32 s36, s52
s_add_u32 s52, s52, 98304
s_cmp_ge_u32 s52, 1966080
s_cselect_b32 s52, 0, s52
s_add_u32 m0, s34, 12288
s_nop 0
buffer_load_dwordx4 v4, s[12:15], s36 offen lds
v_mfma_f32_32x32x16_bf16 v[160:175], v[24:27], v[28:31], v[160:175]
s_add_u32 m0, s34, 13312
s_nop 0
buffer_load_dwordx4 v5, s[12:15], s36 offen lds
v_mfma_f32_32x32x16_bf16 v[176:191], v[24:27], v[32:35], v[176:191]
s_add_u32 m0, s34, 14336
s_nop 0
buffer_load_dwordx4 v6, s[12:15], s36 offen lds
s_waitcnt lgkmcnt(13)
v_mfma_f32_32x32x16_bf16 v[96:111], v[36:39], v[48:51], v[96:111]
s_waitcnt lgkmcnt(12)
v_mfma_f32_32x32x16_bf16 v[112:127], v[36:39], v[52:55], v[112:127]
s_waitcnt lgkmcnt(10)
v_mfma_f32_32x32x16_bf16 v[128:143], v[40:43], v[48:51], v[128:143]
v_mfma_f32_32x32x16_bf16 v[144:159], v[40:43], v[52:55], v[144:159]
s_waitcnt lgkmcnt(8)
v_mfma_f32_32x32x16_bf16 v[160:175], v[44:47], v[48:51], v[160:175]
v_mfma_f32_32x32x16_bf16 v[176:191], v[44:47], v[52:55], v[176:191]
s_waitcnt lgkmcnt(0)
s_waitcnt vmcnt(10)
s_barrier
ds_read_b64_tr_b16 v[16:17], v7 offset:36864
ds_read_b64_tr_b16 v[18:19], v7 offset:37632
ds_read_b128 v[28:31], v12 offset:16384
ds_read_b128 v[32:35], v12 offset:20480
v_mfma_f32_32x32x16_bf16 v[96:111], v[200:203], v[212:215], v[96:111]
ds_read_b64_tr_b16 v[20:21], v8 offset:36864
ds_read_b64_tr_b16 v[22:23], v8 offset:37632
ds_read_b64_tr_b16 v[24:25], v9 offset:36864
ds_read_b64_tr_b16 v[26:27], v9 offset:37632
v_mfma_f32_32x32x16_bf16 v[112:127], v[200:203], v[216:219], v[112:127]
ds_read_b64_tr_b16 v[36:37], v7 offset:39936
ds_read_b64_tr_b16 v[38:39], v7 offset:40704
ds_read_b128 v[48:51], v13 offset:16384
s_mov_b32 s36, s52
s_add_u32 s52, s52, 98304
s_cmp_ge_u32 s52, 1966080
s_cselect_b32 s52, 0, s52
s_add_u32 m0, s34, 24576
s_nop 0
buffer_load_dwordx4 v4, s[12:15], s36 offen lds
v_mfma_f32_32x32x16_bf16 v[128:143], v[204:207], v[212:215], v[128:143]
ds_read_b128 v[52:55], v13 offset:20480
ds_read_b64_tr_b16 v[40:41], v8 offset:39936
ds_read_b64_tr_b16 v[42:43], v8 offset:40704
s_add_u32 m0, s34, 25600
s_nop 0
buffer_load_dwordx4 v5, s[12:15], s36 offen lds
v_mfma_f32_32x32x16_bf16 v[144:159], v[204:207], v[216:219], v[144:159]
ds_read_b64_tr_b16 v[44:45], v9 offset:39936
ds_read_b64_tr_b16 v[46:47], v9 offset:40704
v_mfma_f32_32x32x16_bf16 v[160:175], v[208:211], v[212:215], v[160:175]
s_add_u32 m0, s34, 26624
s_nop 0
buffer_load_dwordx4 v6, s[12:15], s36 offen lds
v_mfma_f32_32x32x16_bf16 v[176:191], v[208:211], v[216:219], v[176:191]
s_waitcnt lgkmcnt(13)
v_mfma_f32_32x32x16_bf16 v[96:111], v[16:19], v[28:31], v[96:111]
s_waitcnt lgkmcnt(12)
v_mfma_f32_32x32x16_bf16 v[112:127], v[16:19], v[32:35], v[112:127]
s_waitcnt lgkmcnt(10)
v_mfma_f32_32x32x16_bf16 v[128:143], v[20:23], v[28:31], v[128:143]
v_mfma_f32_32x32x16_bf16 v[144:159], v[20:23], v[32:35], v[144:159]
s_waitcnt lgkmcnt(8)
v_mfma_f32_32x32x16_bf16 v[160:175], v[24:27], v[28:31], v[160:175]
v_mfma_f32_32x32x16_bf16 v[176:191], v[24:27], v[32:35], v[176:191]
s_waitcnt lgkmcnt(0)
s_waitcnt vmcnt(6)
s_barrier
ds_read_b64_tr_b16 v[200:201], v7 offset:0
ds_read_b64_tr_b16 v[202:203], v7 offset:768
ds_read_b128 v[212:215], v10 offset:0
ds_read_b128 v[216:219], v10 offset:4096
v_mfma_f32_32x32x16_bf16 v[96:111], v[36:39], v[48:51], v[96:111]
ds_read_b64_tr_b16 v[204:205], v8 offset:0
ds_read_b64_tr_b16 v[206:207], v8 offset:768
ds_read_b64_tr_b16 v[208:209], v9 offset:0
ds_read_b64_tr_b16 v[210:211], v9 offset:768
v_mfma_f32_32x32x16_bf16 v[112:127], v[36:39], v[52:55], v[112:127]
ds_read_b64_tr_b16 v[16:17], v7 offset:3072
ds_read_b64_tr_b16 v[18:19], v7 offset:3840
ds_read_b128 v[28:31], v11 offset:0
s_mov_b32 s37, s53
s_add_u32 s53, s53, 128
s_cmp_ge_u32 s53, 1280
s_cselect_b32 s53, 0, s53
s_add_u32 m0, s35, 16384
s_nop 0
buffer_load_dwordx4 v2, s[8:11], s37 offen lds
s_add_u32 m0, s35, 17408
s_nop 0
buffer_load_dwordx4 v3, s[8:11], s37 offen lds
v_mfma_f32_32x32x16_bf16 v[128:143], v[40:43], v[48:51], v[128:143]
ds_read_b128 v[32:35], v11 offset:4096
ds_read_b64_tr_b16 v[20:21], v8 offset:3072
ds_read_b64_tr_b16 v[22:23], v8 offset:3840
s_add_u32 s37, s37, 20480
s_add_u32 m0, s35, 18432
s_nop 0
buffer_load_dwordx4 v2, s[8:11], s37 offen lds
v_mfma_f32_32x32x16_bf16 v[144:159], v[40:43], v[52:55], v[144:159]
ds_read_b64_tr_b16 v[24:25], v9 offset:3072
ds_read_b64_tr_b16 v[26:27], v9 offset:3840
s_add_u32 m0, s35, 19456
s_nop 0
buffer_load_dwordx4 v3, s[8:11], s37 offen lds
s_mov_b32 s36, s52
s_add_u32 s52, s52, 98304
s_cmp_ge_u32 s52, 1966080
s_cselect_b32 s52, 0, s52
s_add_u32 m0, s34, 36864
s_nop 0
buffer_load_dwordx4 v4, s[12:15], s36 offen lds
v_mfma_f32_32x32x16_bf16 v[160:175], v[44:47], v[48:51], v[160:175]
s_add_u32 m0, s34, 37888
s_nop 0
buffer_load_dwordx4 v5, s[12:15], s36 offen lds
v_mfma_f32_32x32x16_bf16 v[176:191], v[44:47], v[52:55], v[176:191]
s_add_u32 m0, s34, 38912
s_nop 0
buffer_load_dwordx4 v6, s[12:15], s36 offen lds
s_waitcnt lgkmcnt(13)
v_mfma_f32_32x32x16_bf16 v[96:111], v[200:203], v[212:215], v[96:111]
s_waitcnt lgkmcnt(12)
v_mfma_f32_32x32x16_bf16 v[112:127], v[200:203], v[216:219], v[112:127]
s_waitcnt lgkmcnt(10)
v_mfma_f32_32x32x16_bf16 v[128:143], v[204:207], v[212:215], v[128:143]
v_mfma_f32_32x32x16_bf16 v[144:159], v[204:207], v[216:219], v[144:159]
s_waitcnt lgkmcnt(8)
v_mfma_f32_32x32x16_bf16 v[160:175], v[208:211], v[212:215], v[160:175]
v_mfma_f32_32x32x16_bf16 v[176:191], v[208:211], v[216:219], v[176:191]
s_waitcnt lgkmcnt(0)
s_waitcnt vmcnt(10)
s_barrier
ds_read_b64_tr_b16 v[36:37], v7 offset:12288
ds_read_b64_tr_b16 v[38:39], v7 offset:13056
ds_read_b128 v[48:51], v12 offset:0
ds_read_b128 v[52:55], v12 offset:4096
v_mfma_f32_32x32x16_bf16 v[96:111], v[16:19], v[28:31], v[96:111]
ds_read_b64_tr_b16 v[40:41], v8 offset:12288
ds_read_b64_tr_b16 v[42:43], v8 offset:13056
ds_read_b64_tr_b16 v[44:45], v9 offset:12288
ds_read_b64_tr_b16 v[46:47], v9 offset:13056
v_mfma_f32_32x32x16_bf16 v[112:127], v[16:19], v[32:35], v[112:127]
ds_read_b64_tr_b16 v[200:201], v7 offset:15360
ds_read_b64_tr_b16 v[202:203], v7 offset:16128
ds_read_b128 v[212:215], v13 offset:0
v_mfma_f32_32x32x16_bf16 v[128:143], v[20:23], v[28:31], v[128:143]
ds_read_b128 v[216:219], v13 offset:4096
ds_read_b64_tr_b16 v[204:205], v8 offset:15360
ds_read_b64_tr_b16 v[206:207], v8 offset:16128
v_mfma_f32_32x32x16_bf16 v[144:159], v[20:23], v[32:35], v[144:159]
ds_read_b64_tr_b16 v[208:209], v9 offset:15360
ds_read_b64_tr_b16 v[210:211], v9 offset:16128
v_mfma_f32_32x32x16_bf16 v[160:175], v[24:27], v[28:31], v[160:175]
v_mfma_f32_32x32x16_bf16 v[176:191], v[24:27], v[32:35], v[176:191]
s_waitcnt lgkmcnt(13)
v_mfma_f32_32x32x16_bf16 v[96:111], v[36:39], v[48:51], v[96:111]
s_waitcnt lgkmcnt(12)
v_mfma_f32_32x32x16_bf16 v[112:127], v[36:39], v[52:55], v[112:127]
s_waitcnt lgkmcnt(10)
v_mfma_f32_32x32x16_bf16 v[128:143], v[40:43], v[48:51], v[128:143]
v_mfma_f32_32x32x16_bf16 v[144:159], v[40:43], v[52:55], v[144:159]
s_waitcnt lgkmcnt(8)
v_mfma_f32_32x32x16_bf16 v[160:175], v[44:47], v[48:51], v[160:175]
v_mfma_f32_32x32x16_bf16 v[176:191], v[44:47], v[52:55], v[176:191]
s_waitcnt lgkmcnt(0)
s_waitcnt vmcnt(3)
s_barrier
ds_read_b64_tr_b16 v[16:17], v7 offset:24576
ds_read_b64_tr_b16 v[18:19], v7 offset:25344
ds_read_b128 v[28:31], v10 offset:16384
ds_read_b128 v[32:35], v10 offset:20480
v_mfma_f32_32x32x16_bf16 v[96:111], v[200:203], v[212:215], v[96:111]
ds_read_b64_tr_b16 v[20:21], v8 offset:24576
ds_read_b64_tr_b16 v[22:23], v8 offset:25344
ds_read_b64_tr_b16 v[24:25], v9 offset:24576
ds_read_b64_tr_b16 v[26:27], v9 offset:25344
v_mfma_f32_32x32x16_bf16 v[112:127], v[200:203], v[216:219], v[112:127]
ds_read_b64_tr_b16 v[36:37], v7 offset:27648
ds_read_b64_tr_b16 v[38:39], v7 offset:28416
ds_read_b128 v[48:51], v11 offset:16384
v_mfma_f32_32x32x16_bf16 v[128:143], v[204:207], v[212:215], v[128:143]
ds_read_b128 v[52:55], v11 offset:20480
ds_read_b64_tr_b16 v[40:41], v8 offset:27648
ds_read_b64_tr_b16 v[42:43], v8 offset:28416
v_mfma_f32_32x32x16_bf16 v[144:159], v[204:207], v[216:219], v[144:159]
ds_read_b64_tr_b16 v[44:45], v9 offset:27648
ds_read_b64_tr_b16 v[46:47], v9 offset:28416
v_mfma_f32_32x32x16_bf16 v[160:175], v[208:211], v[212:215], v[160:175]
v_mfma_f32_32x32x16_bf16 v[176:191], v[208:211], v[216:219], v[176:191]
s_waitcnt lgkmcnt(13)
v_mfma_f32_32x32x16_bf16 v[96:111], v[16:19], v[28:31], v[96:111]
s_waitcnt lgkmcnt(12)
v_mfma_f32_32x32x16_bf16 v[112:127], v[16:19], v[32:35], v[112:127]
s_waitcnt lgkmcnt(10)
v_mfma_f32_32x32x16_bf16 v[128:143], v[20:23], v[28:31], v[128:143]
v_mfma_f32_32x32x16_bf16 v[144:159], v[20:23], v[32:35], v[144:159]
s_waitcnt lgkmcnt(8)
v_mfma_f32_32x32x16_bf16 v[160:175], v[24:27], v[28:31], v[160:175]
v_mfma_f32_32x32x16_bf16 v[176:191], v[24:27], v[32:35], v[176:191]
s_waitcnt lgkmcnt(0)
s_waitcnt vmcnt(0)
s_barrier
ds_read_b64_tr_b16 v[200:201], v7 offset:36864
ds_read_b64_tr_b16 v[202:203], v7 offset:37632
ds_read_b128 v[212:215], v12 offset:16384
ds_read_b128 v[216:219], v12 offset:20480
v_mfma_f32_32x32x16_bf16 v[96:111], v[36:39], v[48:51], v[96:111]
ds_read_b64_tr_b16 v[204:205], v8 offset:36864
ds_read_b64_tr_b16 v[206:207], v8 offset:37632
ds_read_b64_tr_b16 v[208:209], v9 offset:36864
ds_read_b64_tr_b16 v[210:211], v9 offset:37632
v_mfma_f32_32x32x16_bf16 v[112:127], v[36:39], v[52:55], v[112:127]
ds_read_b64_tr_b16 v[16:17], v7 offset:39936
ds_read_b64_tr_b16 v[18:19], v7 offset:40704
ds_read_b128 v[28:31], v13 offset:16384
v_mfma_f32_32x32x16_bf16 v[128:143], v[40:43], v[48:51], v[128:143]
ds_read_b128 v[32:35], v13 offset:20480
ds_read_b64_tr_b16 v[20:21], v8 offset:39936
ds_read_b64_tr_b16 v[22:23], v8 offset:40704
v_mfma_f32_32x32x16_bf16 v[144:159], v[40:43], v[52:55], v[144:159]
ds_read_b64_tr_b16 v[24:25], v9 offset:39936
ds_read_b64_tr_b16 v[26:27], v9 offset:40704
v_mfma_f32_32x32x16_bf16 v[160:175], v[44:47], v[48:51], v[160:175]
v_mfma_f32_32x32x16_bf16 v[176:191], v[44:47], v[52:55], v[176:191]
s_waitcnt lgkmcnt(13)
v_mfma_f32_32x32x16_bf16 v[96:111], v[200:203], v[212:215], v[96:111]
s_waitcnt lgkmcnt(12)
v_mfma_f32_32x32x16_bf16 v[112:127], v[200:203], v[216:219], v[112:127]
s_waitcnt lgkmcnt(10)
v_mfma_f32_32x32x16_bf16 v[128:143], v[204:207], v[212:215], v[128:143]
v_mfma_f32_32x32x16_bf16 v[144:159], v[204:207], v[216:219], v[144:159]
s_waitcnt lgkmcnt(8)
v_mfma_f32_32x32x16_bf16 v[160:175], v[208:211], v[212:215], v[160:175]
v_mfma_f32_32x32x16_bf16 v[176:191], v[208:211], v[216:219], v[176:191]
s_waitcnt lgkmcnt(5)
v_mfma_f32_32x32x16_bf16 v[96:111], v[16:19], v[28:31], v[96:111]
s_waitcnt lgkmcnt(4)
v_mfma_f32_32x32x16_bf16 v[112:127], v[16:19], v[32:35], v[112:127]
s_waitcnt lgkmcnt(2)
v_mfma_f32_32x32x16_bf16 v[128:143], v[20:23], v[28:31], v[128:143]
v_mfma_f32_32x32x16_bf16 v[144:159], v[20:23], v[32:35], v[144:159]
s_waitcnt lgkmcnt(0)
v_mfma_f32_32x32x16_bf16 v[160:175], v[24:27], v[28:31], v[160:175]
v_mfma_f32_32x32x16_bf16 v[176:191], v[24:27], v[32:35], v[176:191]
s_cmp_eq_u32 s4, 0
s_cbranch_scc0 L_ffn_nonce_2
v_readfirstlane_b32 s58, v251
s_nop 0
s_cmp_lg_u32 s58, 0
s_cbranch_scc1 L_ffn_nonce_2
s_load_dwordx2 s[60:61], s[0:1], 120
v_mov_b32 v250, 0
s_mov_b32 s59, 0
s_waitcnt lgkmcnt(0)
L_nonce_3:
global_load_dword v251, v250, s[60:61] sc1
s_waitcnt vmcnt(0)
v_readfirstlane_b32 s58, v251
s_add_u32 s59, s59, 1
s_cmp_lg_u32 s58, 0
s_cbranch_scc1 L_nonced_4
s_cmp_lt_u32 s59, 16384
s_cbranch_scc0 L_to_5
s_sleep 2
s_branch L_nonce_3
L_to_5:
L_nonced_4:
L_ffn_nonce_2:
s_add_u32 s20, s32, 0x1220000
s_addc_u32 s21, s33, 0
s_mov_b32 s22, 0x2000
s_mov_b32 s23, 0x20000
s_lshl_b32 s50, s40, 4
s_add_u32 s50, s50, s41
s_lshl_b32 s50, s50, 2
s_add_u32 s49, s50, 3072
s_and_b32 s51, s5, 1
s_lshl_b32 s51, s51, 2
s_lshr_b32 s7, s6, 3
s_add_u32 s51, s51, s7
s_lshr_b32 s51, s51, 1
s_mul_i32 s51, s51, 192
s_add_u32 s51, s51, 2048
s_cmp_eq_u32 s4, 0
s_cbranch_scc0 L_w2a_6
v_lshlrev_b32 v248, 2, v1
s_mov_b32 exec_lo, 0xffffffff
s_mov_b32 exec_hi, 0xffff
buffer_load_dword v252, v248, s[20:23], s51 offen sc1
s_mov_b64 exec, -1
L_w2a_6:
s_mov_b32 s38, 0xbfb8aa3b
s_mov_b32 s39, 0xbfb8aa3b
s_mul_i32 s42, s41, 6
s_mul_i32 s43, s26, 3
s_add_u32 s42, s42, s43
s_lshl_b32 s43, s40, 3
s_lshl_b32 s44, s27, 2
s_add_u32 s43, s43, s44
s_add_u32 s44, s42, 0
s_lshr_b32 s45, s44, 1
s_and_b32 s44, s44, 1
s_lshl_b32 s44, s44, 9
v_mul_f32 v56, s38, v96
v_mul_f32 v57, s38, v97
v_exp_f32 v56, v56
v_exp_f32 v57, v57
v_mul_f32 v58, v96, v104
v_mul_f32 v59, v97, v105
v_add_f32 v56, 1.0, v56
v_add_f32 v57, 1.0, v57
v_rcp_f32 v56, v56
v_rcp_f32 v57, v57
s_nop 0
v_mul_f32 v58, v58, v56
v_mul_f32 v59, v59, v57
v_cvt_pk_bf16_f32 v72, v58, v59
v_mul_f32 v60, s38, v98
v_mul_f32 v61, s38, v99
v_exp_f32 v60, v60
v_exp_f32 v61, v61
v_mul_f32 v62, v98, v106
v_mul_f32 v63, v99, v107
v_add_f32 v60, 1.0, v60
v_add_f32 v61, 1.0, v61
v_rcp_f32 v60, v60
v_rcp_f32 v61, v61
s_nop 0
v_mul_f32 v62, v62, v60
v_mul_f32 v63, v63, v61
v_cvt_pk_bf16_f32 v73, v62, v63
v_mul_f32 v56, s38, v100
v_mul_f32 v57, s38, v101
v_exp_f32 v56, v56
v_exp_f32 v57, v57
v_mul_f32 v58, v100, v108
v_mul_f32 v59, v101, v109
v_add_f32 v56, 1.0, v56
v_add_f32 v57, 1.0, v57
v_rcp_f32 v56, v56
v_rcp_f32 v57, v57
s_nop 0
v_mul_f32 v58, v58, v56
v_mul_f32 v59, v59, v57
v_cvt_pk_bf16_f32 v74, v58, v59
v_mul_f32 v60, s38, v102
v_mul_f32 v61, s38, v103
v_exp_f32 v60, v60
v_exp_f32 v61, v61
v_mul_f32 v62, v102, v110
v_mul_f32 v63, v103, v111
v_add_f32 v60, 1.0, v60
v_add_f32 v61, 1.0, v61
v_rcp_f32 v60, v60
v_rcp_f32 v61, v61
s_nop 0
v_mul_f32 v62, v62, v60
v_mul_f32 v63, v63, v61
v_cvt_pk_bf16_f32 v75, v62, v63
s_add_u32 s46, s43, 0
s_mul_i32 s46, s46, 48
s_add_u32 s46, s46, s45
s_lshl_b32 s46, s46, 10
s_add_u32 s46, s46, s44
buffer_store_dwordx4 v[72:75], v14, s[16:19], s46 offen sc1
v_mul_f32 v56, s38, v112
v_mul_f32 v57, s38, v113
v_exp_f32 v56, v56
v_exp_f32 v57, v57
v_mul_f32 v58, v112, v120
v_mul_f32 v59, v113, v121
v_add_f32 v56, 1.0, v56
v_add_f32 v57, 1.0, v57
v_rcp_f32 v56, v56
v_rcp_f32 v57, v57
s_nop 0
v_mul_f32 v58, v58, v56
v_mul_f32 v59, v59, v57
v_cvt_pk_bf16_f32 v76, v58, v59
v_mul_f32 v60, s38, v114
v_mul_f32 v61, s38, v115
v_exp_f32 v60, v60
v_exp_f32 v61, v61
v_mul_f32 v62, v114, v122
v_mul_f32 v63, v115, v123
v_add_f32 v60, 1.0, v60
v_add_f32 v61, 1.0, v61
v_rcp_f32 v60, v60
v_rcp_f32 v61, v61
s_nop 0
v_mul_f32 v62, v62, v60
v_mul_f32 v63, v63, v61
v_cvt_pk_bf16_f32 v77, v62, v63
v_mul_f32 v56, s38, v116
v_mul_f32 v57, s38, v117
v_exp_f32 v56, v56
v_exp_f32 v57, v57
v_mul_f32 v58, v116, v124
v_mul_f32 v59, v117, v125
v_add_f32 v56, 1.0, v56
v_add_f32 v57, 1.0, v57
v_rcp_f32 v56, v56
v_rcp_f32 v57, v57
s_nop 0
v_mul_f32 v58, v58, v56
v_mul_f32 v59, v59, v57
v_cvt_pk_bf16_f32 v78, v58, v59
v_mul_f32 v60, s38, v118
v_mul_f32 v61, s38, v119
v_exp_f32 v60, v60
v_exp_f32 v61, v61
v_mul_f32 v62, v118, v126
v_mul_f32 v63, v119, v127
v_add_f32 v60, 1.0, v60
v_add_f32 v61, 1.0, v61
v_rcp_f32 v60, v60
v_rcp_f32 v61, v61
s_nop 0
v_mul_f32 v62, v62, v60
v_mul_f32 v63, v63, v61
v_cvt_pk_bf16_f32 v79, v62, v63
s_add_u32 s46, s43, 2
s_mul_i32 s46, s46, 48
s_add_u32 s46, s46, s45
s_lshl_b32 s46, s46, 10
s_add_u32 s46, s46, s44
buffer_store_dwordx4 v[76:79], v14, s[16:19], s46 offen sc1
s_add_u32 s44, s42, 1
s_lshr_b32 s45, s44, 1
s_and_b32 s44, s44, 1
s_lshl_b32 s44, s44, 9
v_mul_f32 v56, s38, v128
v_mul_f32 v57, s38, v129
v_exp_f32 v56, v56
v_exp_f32 v57, v57
v_mul_f32 v58, v128, v136
v_mul_f32 v59, v129, v137
v_add_f32 v56, 1.0, v56
v_add_f32 v57, 1.0, v57
v_rcp_f32 v56, v56
v_rcp_f32 v57, v57
s_nop 0
v_mul_f32 v58, v58, v56
v_mul_f32 v59, v59, v57
v_cvt_pk_bf16_f32 v72, v58, v59
v_mul_f32 v60, s38, v130
v_mul_f32 v61, s38, v131
v_exp_f32 v60, v60
v_exp_f32 v61, v61
v_mul_f32 v62, v130, v138
v_mul_f32 v63, v131, v139
v_add_f32 v60, 1.0, v60
v_add_f32 v61, 1.0, v61
v_rcp_f32 v60, v60
v_rcp_f32 v61, v61
s_nop 0
v_mul_f32 v62, v62, v60
v_mul_f32 v63, v63, v61
v_cvt_pk_bf16_f32 v73, v62, v63
v_mul_f32 v56, s38, v132
v_mul_f32 v57, s38, v133
v_exp_f32 v56, v56
v_exp_f32 v57, v57
v_mul_f32 v58, v132, v140
v_mul_f32 v59, v133, v141
v_add_f32 v56, 1.0, v56
v_add_f32 v57, 1.0, v57
v_rcp_f32 v56, v56
v_rcp_f32 v57, v57
s_nop 0
v_mul_f32 v58, v58, v56
v_mul_f32 v59, v59, v57
v_cvt_pk_bf16_f32 v74, v58, v59
v_mul_f32 v60, s38, v134
v_mul_f32 v61, s38, v135
v_exp_f32 v60, v60
v_exp_f32 v61, v61
v_mul_f32 v62, v134, v142
v_mul_f32 v63, v135, v143
v_add_f32 v60, 1.0, v60
v_add_f32 v61, 1.0, v61
v_rcp_f32 v60, v60
v_rcp_f32 v61, v61
s_nop 0
v_mul_f32 v62, v62, v60
v_mul_f32 v63, v63, v61
v_cvt_pk_bf16_f32 v75, v62, v63
s_add_u32 s46, s43, 0
s_mul_i32 s46, s46, 48
s_add_u32 s46, s46, s45
s_lshl_b32 s46, s46, 10
s_add_u32 s46, s46, s44
buffer_store_dwordx4 v[72:75], v14, s[16:19], s46 offen sc1
v_mul_f32 v56, s38, v144
v_mul_f32 v57, s38, v145
v_exp_f32 v56, v56
v_exp_f32 v57, v57
v_mul_f32 v58, v144, v152
v_mul_f32 v59, v145, v153
v_add_f32 v56, 1.0, v56
v_add_f32 v57, 1.0, v57
v_rcp_f32 v56, v56
v_rcp_f32 v57, v57
s_nop 0
v_mul_f32 v58, v58, v56
v_mul_f32 v59, v59, v57
v_cvt_pk_bf16_f32 v76, v58, v59
v_mul_f32 v60, s38, v146
v_mul_f32 v61, s38, v147
v_exp_f32 v60, v60
v_exp_f32 v61, v61
v_mul_f32 v62, v146, v154
v_mul_f32 v63, v147, v155
v_add_f32 v60, 1.0, v60
v_add_f32 v61, 1.0, v61
v_rcp_f32 v60, v60
v_rcp_f32 v61, v61
s_nop 0
v_mul_f32 v62, v62, v60
v_mul_f32 v63, v63, v61
v_cvt_pk_bf16_f32 v77, v62, v63
v_mul_f32 v56, s38, v148
v_mul_f32 v57, s38, v149
v_exp_f32 v56, v56
v_exp_f32 v57, v57
v_mul_f32 v58, v148, v156
v_mul_f32 v59, v149, v157
v_add_f32 v56, 1.0, v56
v_add_f32 v57, 1.0, v57
v_rcp_f32 v56, v56
v_rcp_f32 v57, v57
s_nop 0
v_mul_f32 v58, v58, v56
v_mul_f32 v59, v59, v57
v_cvt_pk_bf16_f32 v78, v58, v59
v_mul_f32 v60, s38, v150
v_mul_f32 v61, s38, v151
v_exp_f32 v60, v60
v_exp_f32 v61, v61
v_mul_f32 v62, v150, v158
v_mul_f32 v63, v151, v159
v_add_f32 v60, 1.0, v60
v_add_f32 v61, 1.0, v61
v_rcp_f32 v60, v60
v_rcp_f32 v61, v61
s_nop 0
v_mul_f32 v62, v62, v60
v_mul_f32 v63, v63, v61
v_cvt_pk_bf16_f32 v79, v62, v63
s_add_u32 s46, s43, 2
s_mul_i32 s46, s46, 48
s_add_u32 s46, s46, s45
s_lshl_b32 s46, s46, 10
s_add_u32 s46, s46, s44
buffer_store_dwordx4 v[76:79], v14, s[16:19], s46 offen sc1
s_add_u32 s44, s42, 2
s_lshr_b32 s45, s44, 1
s_and_b32 s44, s44, 1
s_lshl_b32 s44, s44, 9
v_mul_f32 v56, s38, v160
v_mul_f32 v57, s38, v161
v_exp_f32 v56, v56
v_exp_f32 v57, v57
v_mul_f32 v58, v160, v168
v_mul_f32 v59, v161, v169
v_add_f32 v56, 1.0, v56
v_add_f32 v57, 1.0, v57
v_rcp_f32 v56, v56
v_rcp_f32 v57, v57
s_nop 0
v_mul_f32 v58, v58, v56
v_mul_f32 v59, v59, v57
v_cvt_pk_bf16_f32 v72, v58, v59
v_mul_f32 v60, s38, v162
v_mul_f32 v61, s38, v163
v_exp_f32 v60, v60
v_exp_f32 v61, v61
v_mul_f32 v62, v162, v170
v_mul_f32 v63, v163, v171
v_add_f32 v60, 1.0, v60
v_add_f32 v61, 1.0, v61
v_rcp_f32 v60, v60
v_rcp_f32 v61, v61
s_nop 0
v_mul_f32 v62, v62, v60
v_mul_f32 v63, v63, v61
v_cvt_pk_bf16_f32 v73, v62, v63
v_mul_f32 v56, s38, v164
v_mul_f32 v57, s38, v165
v_exp_f32 v56, v56
v_exp_f32 v57, v57
v_mul_f32 v58, v164, v172
v_mul_f32 v59, v165, v173
v_add_f32 v56, 1.0, v56
v_add_f32 v57, 1.0, v57
v_rcp_f32 v56, v56
v_rcp_f32 v57, v57
s_nop 0
v_mul_f32 v58, v58, v56
v_mul_f32 v59, v59, v57
v_cvt_pk_bf16_f32 v74, v58, v59
v_mul_f32 v60, s38, v166
v_mul_f32 v61, s38, v167
v_exp_f32 v60, v60
v_exp_f32 v61, v61
v_mul_f32 v62, v166, v174
v_mul_f32 v63, v167, v175
v_add_f32 v60, 1.0, v60
v_add_f32 v61, 1.0, v61
v_rcp_f32 v60, v60
v_rcp_f32 v61, v61
s_nop 0
v_mul_f32 v62, v62, v60
v_mul_f32 v63, v63, v61
v_cvt_pk_bf16_f32 v75, v62, v63
s_add_u32 s46, s43, 0
s_mul_i32 s46, s46, 48
s_add_u32 s46, s46, s45
s_lshl_b32 s46, s46, 10
s_add_u32 s46, s46, s44
buffer_store_dwordx4 v[72:75], v14, s[16:19], s46 offen sc1
v_mul_f32 v56, s38, v176
v_mul_f32 v57, s38, v177
v_exp_f32 v56, v56
v_exp_f32 v57, v57
v_mul_f32 v58, v176, v184
v_mul_f32 v59, v177, v185
v_add_f32 v56, 1.0, v56
v_add_f32 v57, 1.0, v57
v_rcp_f32 v56, v56
v_rcp_f32 v57, v57
s_nop 0
v_mul_f32 v58, v58, v56
v_mul_f32 v59, v59, v57
v_cvt_pk_bf16_f32 v76, v58, v59
v_mul_f32 v60, s38, v178
v_mul_f32 v61, s38, v179
v_exp_f32 v60, v60
v_exp_f32 v61, v61
v_mul_f32 v62, v178, v186
v_mul_f32 v63, v179, v187
v_add_f32 v60, 1.0, v60
v_add_f32 v61, 1.0, v61
v_rcp_f32 v60, v60
v_rcp_f32 v61, v61
s_nop 0
v_mul_f32 v62, v62, v60
v_mul_f32 v63, v63, v61
v_cvt_pk_bf16_f32 v77, v62, v63
v_mul_f32 v56, s38, v180
v_mul_f32 v57, s38, v181
v_exp_f32 v56, v56
v_exp_f32 v57, v57
v_mul_f32 v58, v180, v188
v_mul_f32 v59, v181, v189
v_add_f32 v56, 1.0, v56
v_add_f32 v57, 1.0, v57
v_rcp_f32 v56, v56
v_rcp_f32 v57, v57
s_nop 0
v_mul_f32 v58, v58, v56
v_mul_f32 v59, v59, v57
v_cvt_pk_bf16_f32 v78, v58, v59
v_mul_f32 v60, s38, v182
v_mul_f32 v61, s38, v183
v_exp_f32 v60, v60
v_exp_f32 v61, v61
v_mul_f32 v62, v182, v190
v_mul_f32 v63, v183, v191
v_add_f32 v60, 1.0, v60
v_add_f32 v61, 1.0, v61
v_rcp_f32 v60, v60
v_rcp_f32 v61, v61
s_nop 0
v_mul_f32 v62, v62, v60
v_mul_f32 v63, v63, v61
v_cvt_pk_bf16_f32 v79, v62, v63
s_add_u32 s46, s43, 2
s_mul_i32 s46, s46, 48
s_add_u32 s46, s46, s45
s_lshl_b32 s46, s46, 10
s_add_u32 s46, s46, s44
buffer_store_dwordx4 v[76:79], v14, s[16:19], s46 offen sc1
s_setprio 1
s_lshr_b32 s40, s5, 1
s_lshl_b32 s40, s40, 3
s_and_b32 s7, s6, 7
s_add_u32 s40, s40, s7
s_and_b32 s41, s5, 1
s_lshl_b32 s41, s41, 2
s_lshr_b32 s7, s6, 3
s_add_u32 s41, s41, s7
v_lshlrev_b32 v2, 4, v1
s_and_b32 s26, s4, 1
s_lshr_b32 s27, s4, 1
s_mul_i32 s28, s41, 245760
s_mul_i32 s29, s4, 5120
s_add_u32 s28, s28, s29
s_lshl_b32 s30, s40, 2
s_lshl_b32 s31, s26, 1
s_add_u32 s30, s30, s31
s_mul_i32 s30, s30, 48
s_lshl_b32 s31, s27, 1
s_add_u32 s30, s30, s31
s_lshl_b32 s30, s30, 10
s_mul_i32 s31, s27, 10240
v_add_u32 v3, s31, v2
v_add_u32 v15, 40960, v3
s_add_u32 s8, s32, 0x600000
s_addc_u32 s9, s33, 0
s_mov_b32 s10, 0x1e0000
s_mov_b32 s11, 0x20000
s_mov_b32 s12, s32
s_mov_b32 s13, s33
s_mov_b32 s14, 0x600000
s_mov_b32 s15, 0x20000
s_mov_b32 s62, 0
s_mov_b32 s63, 0
s_waitcnt vmcnt(0)
s_barrier
s_cmp_eq_u32 s4, 0
s_cbranch_scc0 L_noflag_7
v_mov_b32 v250, 0
v_mov_b32 v251, s58
s_mov_b64 exec, 1
buffer_store_dword v251, v250, s[20:23], s49 offen sc1
s_mov_b64 exec, -1
L_noflag_7:
s_lshr_b32 s50, s40, 1
s_lshl_b32 s50, s50, 6
s_add_u32 s50, s50, 3072
s_cmp_eq_u32 s4, 0
s_cbranch_scc0 L_w2c_8
s_waitcnt vmcnt(1)
s_mov_b32 exec_lo, 0xffffffff
s_mov_b32 exec_hi, 0xffff
v_cmp_ne_u32 vcc, s58, v252
s_mov_b64 exec, -1
s_cmp_eq_u64 vcc, 0
s_cbranch_scc1 L_flags_ok_9
v_lshlrev_b32 v248, 2, v1
s_mov_b32 s59, 0
s_mov_b32 exec_lo, 0xffffffff
s_mov_b32 exec_hi, 0xffff
L_poll_10:
buffer_load_dword v250, v248, s[20:23], s51 offen sc1
s_waitcnt vmcnt(0)
v_cmp_ne_u32 vcc, s58, v250
s_nop 1
s_cmp_eq_u64 vcc, 0
s_cbranch_scc1 L_polled_11
s_add_u32 s59, s59, 1
s_cmp_lt_u32 s59, 16384
s_cbranch_scc0 L_to_12
s_sleep 4
s_branch L_poll_10
L_to_12:
L_polled_11:
s_mov_b64 exec, -1
L_flags_ok_9:
L_w2c_8:
s_barrier
s_add_u32 s36, s28, s62
s_add_u32 s62, s62, 20480
s_cmp_ge_u32 s62, 245760
s_cselect_b32 s62, 0, s62
s_add_u32 m0, s29, 0
s_nop 0
buffer_load_dwordx4 v2, s[8:11], s36 offen sc1 lds
s_add_u32 m0, s29, 1024
s_add_u32 s36, s36, 1024
buffer_load_dwordx4 v2, s[8:11], s36 offen sc1 lds
s_add_u32 m0, s29, 2048
s_add_u32 s36, s36, 1024
buffer_load_dwordx4 v2, s[8:11], s36 offen sc1 lds
s_add_u32 m0, s29, 3072
s_add_u32 s36, s36, 1024
buffer_load_dwordx4 v2, s[8:11], s36 offen sc1 lds
s_add_u32 m0, s29, 4096
s_add_u32 s36, s36, 1024
buffer_load_dwordx4 v2, s[8:11], s36 offen sc1 lds
s_add_u32 s36, s28, s62
s_add_u32 s62, s62, 20480
s_cmp_ge_u32 s62, 245760
s_cselect_b32 s62, 0, s62
s_add_u32 m0, s29, 20480
s_nop 0
buffer_load_dwordx4 v2, s[8:11], s36 offen sc1 lds
s_add_u32 m0, s29, 21504
s_add_u32 s36, s36, 1024
buffer_load_dwordx4 v2, s[8:11], s36 offen sc1 lds
s_add_u32 m0, s29, 22528
s_add_u32 s36, s36, 1024
buffer_load_dwordx4 v2, s[8:11], s36 offen sc1 lds
s_add_u32 m0, s29, 23552
s_add_u32 s36, s36, 1024
buffer_load_dwordx4 v2, s[8:11], s36 offen sc1 lds
s_add_u32 m0, s29, 24576
s_add_u32 s36, s36, 1024
buffer_load_dwordx4 v2, s[8:11], s36 offen sc1 lds
s_add_u32 s36, s28, s62
s_add_u32 s62, s62, 20480
s_cmp_ge_u32 s62, 245760
s_cselect_b32 s62, 0, s62
s_add_u32 m0, s29, 40960
s_nop 0
buffer_load_dwordx4 v2, s[8:11], s36 offen sc1 lds
s_add_u32 m0, s29, 41984
s_add_u32 s36, s36, 1024
buffer_load_dwordx4 v2, s[8:11], s36 offen sc1 lds
s_add_u32 m0, s29, 43008
s_add_u32 s36, s36, 1024
buffer_load_dwordx4 v2, s[8:11], s36 offen sc1 lds
s_add_u32 m0, s29, 44032
s_add_u32 s36, s36, 1024
buffer_load_dwordx4 v2, s[8:11], s36 offen sc1 lds
s_add_u32 m0, s29, 45056
s_add_u32 s36, s36, 1024
buffer_load_dwordx4 v2, s[8:11], s36 offen sc1 lds
s_add_u32 s36, s28, s62
s_add_u32 s62, s62, 20480
s_cmp_ge_u32 s62, 245760
s_cselect_b32 s62, 0, s62
s_add_u32 m0, s29, 61440
s_nop 0
buffer_load_dwordx4 v2, s[8:11], s36 offen sc1 lds
s_add_u32 m0, s29, 62464
s_add_u32 s36, s36, 1024
buffer_load_dwordx4 v2, s[8:11], s36 offen sc1 lds
s_add_u32 m0, s29, 63488
s_add_u32 s36, s36, 1024
buffer_load_dwordx4 v2, s[8:11], s36 offen sc1 lds
s_add_u32 m0, s29, 64512
s_add_u32 s36, s36, 1024
buffer_load_dwordx4 v2, s[8:11], s36 offen sc1 lds
s_add_u32 m0, s29, 65536
s_add_u32 s36, s36, 1024
buffer_load_dwordx4 v2, s[8:11], s36 offen sc1 lds
s_cmp_eq_u32 s4, 0
s_cbranch_scc0 L_hpolled_13
v_lshlrev_b32 v248, 2, v1
s_mov_b32 s59, 0
s_mov_b32 exec_lo, 0xffff
s_mov_b32 exec_hi, 0x0
L_poll_14:
buffer_load_dword v250, v248, s[20:23], s50 offen sc1
s_waitcnt vmcnt(0)
v_cmp_ne_u32 vcc, s58, v250
s_nop 1
s_cmp_eq_u64 vcc, 0
s_cbranch_scc1 L_polled_15
s_add_u32 s59, s59, 1
s_cmp_lt_u32 s59, 16384
s_cbranch_scc0 L_to_16
s_sleep 4
s_branch L_poll_14
L_to_16:
L_polled_15:
s_mov_b64 exec, -1
L_hpolled_13:
s_barrier
s_add_u32 s37, s30, s63
s_add_u32 s63, s63, 4096
s_cmp_ge_u32 s63, 49152
s_cselect_b32 s63, 0, s63
s_add_u32 s38, s37, 0
buffer_load_dwordx4 v[56:59], v2, s[12:15], s38 offen sc1
s_add_u32 s38, s37, 49152
buffer_load_dwordx4 v[60:63], v2, s[12:15], s38 offen sc1
s_add_u32 s38, s37, 1024
buffer_load_dwordx4 v[64:67], v2, s[12:15], s38 offen sc1
s_add_u32 s38, s37, 50176
buffer_load_dwordx4 v[68:71], v2, s[12:15], s38 offen sc1
s_add_u32 s37, s30, s63
s_add_u32 s63, s63, 4096
s_cmp_ge_u32 s63, 49152
s_cselect_b32 s63, 0, s63
s_add_u32 s38, s37, 0
buffer_load_dwordx4 v[72:75], v2, s[12:15], s38 offen sc1
s_add_u32 s38, s37, 49152
buffer_load_dwordx4 v[76:79], v2, s[12:15], s38 offen sc1
s_add_u32 s38, s37, 1024
buffer_load_dwordx4 v[80:83], v2, s[12:15], s38 offen sc1
s_add_u32 s38, s37, 50176
buffer_load_dwordx4 v[84:87], v2, s[12:15], s38 offen sc1
v_mov_b32 v104, 0
v_mov_b32 v105, 0
v_mov_b32 v106, 0
v_mov_b32 v107, 0
v_mov_b32 v108, 0
v_mov_b32 v109, 0
v_mov_b32 v110, 0
v_mov_b32 v111, 0
v_mov_b32 v112, 0
v_mov_b32 v113, 0
v_mov_b32 v114, 0
v_mov_b32 v115, 0
v_mov_b32 v116, 0
v_mov_b32 v117, 0
v_mov_b32 v118, 0
v_mov_b32 v119, 0
v_mov_b32 v120, 0
v_mov_b32 v121, 0
v_mov_b32 v122, 0
v_mov_b32 v123, 0
v_mov_b32 v124, 0
v_mov_b32 v125, 0
v_mov_b32 v126, 0
v_mov_b32 v127, 0
v_mov_b32 v128, 0
v_mov_b32 v129, 0
v_mov_b32 v130, 0
v_mov_b32 v131, 0
v_mov_b32 v132, 0
v_mov_b32 v133, 0
v_mov_b32 v134, 0
v_mov_b32 v135, 0
v_mov_b32 v136, 0
v_mov_b32 v137, 0
v_mov_b32 v138, 0
v_mov_b32 v139, 0
v_mov_b32 v140, 0
v_mov_b32 v141, 0
v_mov_b32 v142, 0
v_mov_b32 v143, 0
s_lshl_b32 s42, s40, 6
s_lshl_b32 s43, s26, 5
s_add_u32 s42, s42, s43
s_lshl_b32 s43, s27, 4
s_add_u32 s42, s42, s43
v_and_b32 v6, 15, v1
v_add_u32 v6, s42, v6
v_lshrrev_b32 v7, 4, v1
s_mul_i32 s43, s41, 80
v_lshlrev_b32 v8, 2, v7
v_add_u32 v8, s43, v8
v_lshlrev_b32 v9, 12, v8
v_lshl_add_u32 v9, v6, 1, v9
v_mul_u32_u24 v10, 1280, v6
v_lshl_add_u32 v10, v8, 1, v10
v_lshlrev_b32 v11, 2, v6
s_load_dwordx2 s[34:35], s[0:1], 112
s_mul_i32 s48, s41, 320
s_add_u32 s48, s48, 4096
s_lshl_b32 s49, s40, 4
s_add_u32 s49, s49, 1536
s_waitcnt lgkmcnt(0)
s_mov_b32 s44, s34
s_mov_b32 s45, s35
s_mov_b32 s46, 0x280000
s_mov_b32 s47, 0x20000
s_waitcnt vmcnt(4)
s_barrier
ds_read_b128 v[16:19], v3 offset:0
ds_read_b128 v[20:23], v3 offset:1024
ds_read_b128 v[24:27], v3 offset:2048
ds_read_b128 v[28:31], v3 offset:3072
ds_read_b128 v[32:35], v3 offset:4096
s_waitcnt lgkmcnt(4)
v_mfma_f32_16x16x32_bf16 v[104:107], v[16:19], v[56:59], v[104:107]
ds_read_b128 v[36:39], v3 offset:5120
v_mfma_f32_16x16x32_bf16 v[124:127], v[16:19], v[60:63], v[124:127]
ds_read_b128 v[40:43], v3 offset:6144
s_add_u32 s37, s30, s63
s_add_u32 s63, s63, 4096
s_cmp_ge_u32 s63, 49152
s_cselect_b32 s63, 0, s63
s_add_u32 s38, s37, 0
buffer_load_dwordx4 v[88:91], v2, s[12:15], s38 offen sc1
s_waitcnt lgkmcnt(5)
v_mfma_f32_16x16x32_bf16 v[108:111], v[20:23], v[56:59], v[108:111]
ds_read_b128 v[44:47], v3 offset:7168
v_mfma_f32_16x16x32_bf16 v[128:131], v[20:23], v[60:63], v[128:131]
ds_read_b128 v[48:51], v3 offset:8192
s_add_u32 s38, s37, 49152
buffer_load_dwordx4 v[92:95], v2, s[12:15], s38 offen sc1
s_waitcnt lgkmcnt(6)
v_mfma_f32_16x16x32_bf16 v[112:115], v[24:27], v[56:59], v[112:115]
ds_read_b128 v[52:55], v3 offset:9216
v_mfma_f32_16x16x32_bf16 v[132:135], v[24:27], v[60:63], v[132:135]
s_add_u32 s38, s37, 1024
buffer_load_dwordx4 v[96:99], v2, s[12:15], s38 offen sc1
s_waitcnt lgkmcnt(6)
v_mfma_f32_16x16x32_bf16 v[116:119], v[28:31], v[56:59], v[116:119]
v_mfma_f32_16x16x32_bf16 v[136:139], v[28:31], v[60:63], v[136:139]
s_add_u32 s38, s37, 50176
buffer_load_dwordx4 v[100:103], v2, s[12:15], s38 offen sc1
s_waitcnt lgkmcnt(5)
v_mfma_f32_16x16x32_bf16 v[120:123], v[32:35], v[56:59], v[120:123]
v_mfma_f32_16x16x32_bf16 v[140:143], v[32:35], v[60:63], v[140:143]
s_waitcnt lgkmcnt(0)
s_barrier
v_mfma_f32_16x16x32_bf16 v[104:107], v[36:39], v[64:67], v[104:107]
ds_read_b128 v[16:19], v3 offset:20480
v_mfma_f32_16x16x32_bf16 v[124:127], v[36:39], v[68:71], v[124:127]
ds_read_b128 v[20:23], v3 offset:21504
s_add_u32 s36, s28, s62
s_add_u32 s62, s62, 20480
s_cmp_ge_u32 s62, 245760
s_cselect_b32 s62, 0, s62
s_add_u32 m0, s29, 0
s_nop 0
buffer_load_dwordx4 v2, s[8:11], s36 offen sc1 lds
v_mfma_f32_16x16x32_bf16 v[108:111], v[40:43], v[64:67], v[108:111]
ds_read_b128 v[24:27], v3 offset:22528
v_mfma_f32_16x16x32_bf16 v[128:131], v[40:43], v[68:71], v[128:131]
ds_read_b128 v[28:31], v3 offset:23552
s_add_u32 m0, s29, 1024
s_add_u32 s36, s36, 1024
buffer_load_dwordx4 v2, s[8:11], s36 offen sc1 lds
v_mfma_f32_16x16x32_bf16 v[112:115], v[44:47], v[64:67], v[112:115]
ds_read_b128 v[32:35], v3 offset:24576
v_mfma_f32_16x16x32_bf16 v[132:135], v[44:47], v[68:71], v[132:135]
s_add_u32 m0, s29, 2048
s_add_u32 s36, s36, 1024
buffer_load_dwordx4 v2, s[8:11], s36 offen sc1 lds
v_mfma_f32_16x16x32_bf16 v[116:119], v[48:51], v[64:67], v[116:119]
v_mfma_f32_16x16x32_bf16 v[136:139], v[48:51], v[68:71], v[136:139]
s_add_u32 m0, s29, 3072
s_add_u32 s36, s36, 1024
buffer_load_dwordx4 v2, s[8:11], s36 offen sc1 lds
v_mfma_f32_16x16x32_bf16 v[120:123], v[52:55], v[64:67], v[120:123]
v_mfma_f32_16x16x32_bf16 v[140:143], v[52:55], v[68:71], v[140:143]
s_add_u32 m0, s29, 4096
s_add_u32 s36, s36, 1024
buffer_load_dwordx4 v2, s[8:11], s36 offen sc1 lds
s_waitcnt vmcnt(9)
s_waitcnt lgkmcnt(4)
v_mfma_f32_16x16x32_bf16 v[104:107], v[16:19], v[72:75], v[104:107]
ds_read_b128 v[36:39], v3 offset:25600
v_mfma_f32_16x16x32_bf16 v[124:127], v[16:19], v[76:79], v[124:127]
ds_read_b128 v[40:43], v3 offset:26624
s_add_u32 s37, s30, s63
s_add_u32 s63, s63, 4096
s_cmp_ge_u32 s63, 49152
s_cselect_b32 s63, 0, s63
s_add_u32 s38, s37, 0
buffer_load_dwordx4 v[56:59], v2, s[12:15], s38 offen sc1
s_waitcnt lgkmcnt(5)
v_mfma_f32_16x16x32_bf16 v[108:111], v[20:23], v[72:75], v[108:111]
ds_read_b128 v[44:47], v3 offset:27648
v_mfma_f32_16x16x32_bf16 v[128:131], v[20:23], v[76:79], v[128:131]
ds_read_b128 v[48:51], v3 offset:28672
s_add_u32 s38, s37, 49152
buffer_load_dwordx4 v[60:63], v2, s[12:15], s38 offen sc1
s_waitcnt lgkmcnt(6)
v_mfma_f32_16x16x32_bf16 v[112:115], v[24:27], v[72:75], v[112:115]
ds_read_b128 v[52:55], v3 offset:29696
v_mfma_f32_16x16x32_bf16 v[132:135], v[24:27], v[76:79], v[132:135]
s_add_u32 s38, s37, 1024
buffer_load_dwordx4 v[64:67], v2, s[12:15], s38 offen sc1
s_waitcnt lgkmcnt(6)
v_mfma_f32_16x16x32_bf16 v[116:119], v[28:31], v[72:75], v[116:119]
v_mfma_f32_16x16x32_bf16 v[136:139], v[28:31], v[76:79], v[136:139]
s_add_u32 s38, s37, 50176
buffer_load_dwordx4 v[68:71], v2, s[12:15], s38 offen sc1
s_waitcnt lgkmcnt(5)
v_mfma_f32_16x16x32_bf16 v[120:123], v[32:35], v[72:75], v[120:123]
v_mfma_f32_16x16x32_bf16 v[140:143], v[32:35], v[76:79], v[140:143]
s_waitcnt lgkmcnt(0)
s_barrier
v_mfma_f32_16x16x32_bf16 v[104:107], v[36:39], v[80:83], v[104:107]
ds_read_b128 v[16:19], v15 offset:0
v_mfma_f32_16x16x32_bf16 v[124:127], v[36:39], v[84:87], v[124:127]
ds_read_b128 v[20:23], v15 offset:1024
s_add_u32 s36, s28, s62
s_add_u32 s62, s62, 20480
s_cmp_ge_u32 s62, 245760
s_cselect_b32 s62, 0, s62
s_add_u32 m0, s29, 20480
s_nop 0
buffer_load_dwordx4 v2, s[8:11], s36 offen sc1 lds
v_mfma_f32_16x16x32_bf16 v[108:111], v[40:43], v[80:83], v[108:111]
ds_read_b128 v[24:27], v15 offset:2048
v_mfma_f32_16x16x32_bf16 v[128:131], v[40:43], v[84:87], v[128:131]
ds_read_b128 v[28:31], v15 offset:3072
s_add_u32 m0, s29, 21504
s_add_u32 s36, s36, 1024
buffer_load_dwordx4 v2, s[8:11], s36 offen sc1 lds
v_mfma_f32_16x16x32_bf16 v[112:115], v[44:47], v[80:83], v[112:115]
ds_read_b128 v[32:35], v15 offset:4096
v_mfma_f32_16x16x32_bf16 v[132:135], v[44:47], v[84:87], v[132:135]
s_add_u32 m0, s29, 22528
s_add_u32 s36, s36, 1024
buffer_load_dwordx4 v2, s[8:11], s36 offen sc1 lds
v_mfma_f32_16x16x32_bf16 v[116:119], v[48:51], v[80:83], v[116:119]
v_mfma_f32_16x16x32_bf16 v[136:139], v[48:51], v[84:87], v[136:139]
s_add_u32 m0, s29, 23552
s_add_u32 s36, s36, 1024
buffer_load_dwordx4 v2, s[8:11], s36 offen sc1 lds
v_mfma_f32_16x16x32_bf16 v[120:123], v[52:55], v[80:83], v[120:123]
v_mfma_f32_16x16x32_bf16 v[140:143], v[52:55], v[84:87], v[140:143]
s_add_u32 m0, s29, 24576
s_add_u32 s36, s36, 1024
buffer_load_dwordx4 v2, s[8:11], s36 offen sc1 lds
s_waitcnt vmcnt(14)
s_waitcnt lgkmcnt(4)
v_mfma_f32_16x16x32_bf16 v[104:107], v[16:19], v[88:91], v[104:107]
ds_read_b128 v[36:39], v15 offset:5120
v_mfma_f32_16x16x32_bf16 v[124:127], v[16:19], v[92:95], v[124:127]
ds_read_b128 v[40:43], v15 offset:6144
s_add_u32 s37, s30, s63
s_add_u32 s63, s63, 4096
s_cmp_ge_u32 s63, 49152
s_cselect_b32 s63, 0, s63
s_add_u32 s38, s37, 0
buffer_load_dwordx4 v[72:75], v2, s[12:15], s38 offen sc1
s_waitcnt lgkmcnt(5)
v_mfma_f32_16x16x32_bf16 v[108:111], v[20:23], v[88:91], v[108:111]
ds_read_b128 v[44:47], v15 offset:7168
v_mfma_f32_16x16x32_bf16 v[128:131], v[20:23], v[92:95], v[128:131]
ds_read_b128 v[48:51], v15 offset:8192
s_add_u32 s38, s37, 49152
buffer_load_dwordx4 v[76:79], v2, s[12:15], s38 offen sc1
s_waitcnt lgkmcnt(6)
v_mfma_f32_16x16x32_bf16 v[112:115], v[24:27], v[88:91], v[112:115]
ds_read_b128 v[52:55], v15 offset:9216
v_mfma_f32_16x16x32_bf16 v[132:135], v[24:27], v[92:95], v[132:135]
s_add_u32 s38, s37, 1024
buffer_load_dwordx4 v[80:83], v2, s[12:15], s38 offen sc1
s_waitcnt lgkmcnt(6)
v_mfma_f32_16x16x32_bf16 v[116:119], v[28:31], v[88:91], v[116:119]
v_mfma_f32_16x16x32_bf16 v[136:139], v[28:31], v[92:95], v[136:139]
s_add_u32 s38, s37, 50176
buffer_load_dwordx4 v[84:87], v2, s[12:15], s38 offen sc1
s_waitcnt lgkmcnt(5)
v_mfma_f32_16x16x32_bf16 v[120:123], v[32:35], v[88:91], v[120:123]
v_mfma_f32_16x16x32_bf16 v[140:143], v[32:35], v[92:95], v[140:143]
s_waitcnt lgkmcnt(0)
s_barrier
v_mfma_f32_16x16x32_bf16 v[104:107], v[36:39], v[96:99], v[104:107]
ds_read_b128 v[16:19], v15 offset:20480
v_mfma_f32_16x16x32_bf16 v[124:127], v[36:39], v[100:103], v[124:127]
ds_read_b128 v[20:23], v15 offset:21504
s_add_u32 s36, s28, s62
s_add_u32 s62, s62, 20480
s_cmp_ge_u32 s62, 245760
s_cselect_b32 s62, 0, s62
s_add_u32 m0, s29, 40960
s_nop 0
buffer_load_dwordx4 v2, s[8:11], s36 offen sc1 lds
v_mfma_f32_16x16x32_bf16 v[108:111], v[40:43], v[96:99], v[108:111]
ds_read_b128 v[24:27], v15 offset:22528
v_mfma_f32_16x16x32_bf16 v[128:131], v[40:43], v[100:103], v[128:131]
ds_read_b128 v[28:31], v15 offset:23552
s_add_u32 m0, s29, 41984
s_add_u32 s36, s36, 1024
buffer_load_dwordx4 v2, s[8:11], s36 offen sc1 lds
v_mfma_f32_16x16x32_bf16 v[112:115], v[44:47], v[96:99], v[112:115]
ds_read_b128 v[32:35], v15 offset:24576
v_mfma_f32_16x16x32_bf16 v[132:135], v[44:47], v[100:103], v[132:135]
s_add_u32 m0, s29, 43008
s_add_u32 s36, s36, 1024
buffer_load_dwordx4 v2, s[8:11], s36 offen sc1 lds
v_mfma_f32_16x16x32_bf16 v[116:119], v[48:51], v[96:99], v[116:119]
v_mfma_f32_16x16x32_bf16 v[136:139], v[48:51], v[100:103], v[136:139]
s_add_u32 m0, s29, 44032
s_add_u32 s36, s36, 1024
buffer_load_dwordx4 v2, s[8:11], s36 offen sc1 lds
v_mfma_f32_16x16x32_bf16 v[120:123], v[52:55], v[96:99], v[120:123]
v_mfma_f32_16x16x32_bf16 v[140:143], v[52:55], v[100:103], v[140:143]
s_add_u32 m0, s29, 45056
s_add_u32 s36, s36, 1024
buffer_load_dwordx4 v2, s[8:11], s36 offen sc1 lds
s_waitcnt vmcnt(14)
s_waitcnt lgkmcnt(4)
v_mfma_f32_16x16x32_bf16 v[104:107], v[16:19], v[56:59], v[104:107]
ds_read_b128 v[36:39], v15 offset:25600
v_mfma_f32_16x16x32_bf16 v[124:127], v[16:19], v[60:63], v[124:127]
ds_read_b128 v[40:43], v15 offset:26624
s_add_u32 s37, s30, s63
s_add_u32 s63, s63, 4096
s_cmp_ge_u32 s63, 49152
s_cselect_b32 s63, 0, s63
s_add_u32 s38, s37, 0
buffer_load_dwordx4 v[88:91], v2, s[12:15], s38 offen sc1
s_waitcnt lgkmcnt(5)
v_mfma_f32_16x16x32_bf16 v[108:111], v[20:23], v[56:59], v[108:111]
ds_read_b128 v[44:47], v15 offset:27648
v_mfma_f32_16x16x32_bf16 v[128:131], v[20:23], v[60:63], v[128:131]
ds_read_b128 v[48:51], v15 offset:28672
s_add_u32 s38, s37, 49152
buffer_load_dwordx4 v[92:95], v2, s[12:15], s38 offen sc1
s_waitcnt lgkmcnt(6)
v_mfma_f32_16x16x32_bf16 v[112:115], v[24:27], v[56:59], v[112:115]
ds_read_b128 v[52:55], v15 offset:29696
v_mfma_f32_16x16x32_bf16 v[132:135], v[24:27], v[60:63], v[132:135]
s_add_u32 s38, s37, 1024
buffer_load_dwordx4 v[96:99], v2, s[12:15], s38 offen sc1
s_waitcnt lgkmcnt(6)
v_mfma_f32_16x16x32_bf16 v[116:119], v[28:31], v[56:59], v[116:119]
v_mfma_f32_16x16x32_bf16 v[136:139], v[28:31], v[60:63], v[136:139]
s_add_u32 s38, s37, 50176
buffer_load_dwordx4 v[100:103], v2, s[12:15], s38 offen sc1
s_waitcnt lgkmcnt(5)
v_mfma_f32_16x16x32_bf16 v[120:123], v[32:35], v[56:59], v[120:123]
v_mfma_f32_16x16x32_bf16 v[140:143], v[32:35], v[60:63], v[140:143]
s_waitcnt lgkmcnt(0)
s_barrier
v_mfma_f32_16x16x32_bf16 v[104:107], v[36:39], v[64:67], v[104:107]
ds_read_b128 v[16:19], v3 offset:0
v_mfma_f32_16x16x32_bf16 v[124:127], v[36:39], v[68:71], v[124:127]
ds_read_b128 v[20:23], v3 offset:1024
s_add_u32 s36, s28, s62
s_add_u32 s62, s62, 20480
s_cmp_ge_u32 s62, 245760
s_cselect_b32 s62, 0, s62
s_add_u32 m0, s29, 61440
s_nop 0
buffer_load_dwordx4 v2, s[8:11], s36 offen sc1 lds
v_mfma_f32_16x16x32_bf16 v[108:111], v[40:43], v[64:67], v[108:111]
ds_read_b128 v[24:27], v3 offset:2048
v_mfma_f32_16x16x32_bf16 v[128:131], v[40:43], v[68:71], v[128:131]
ds_read_b128 v[28:31], v3 offset:3072
s_add_u32 m0, s29, 62464
s_add_u32 s36, s36, 1024
buffer_load_dwordx4 v2, s[8:11], s36 offen sc1 lds
v_mfma_f32_16x16x32_bf16 v[112:115], v[44:47], v[64:67], v[112:115]
ds_read_b128 v[32:35], v3 offset:4096
v_mfma_f32_16x16x32_bf16 v[132:135], v[44:47], v[68:71], v[132:135]
s_add_u32 m0, s29, 63488
s_add_u32 s36, s36, 1024
buffer_load_dwordx4 v2, s[8:11], s36 offen sc1 lds
v_mfma_f32_16x16x32_bf16 v[116:119], v[48:51], v[64:67], v[116:119]
v_mfma_f32_16x16x32_bf16 v[136:139], v[48:51], v[68:71], v[136:139]
s_add_u32 m0, s29, 64512
s_add_u32 s36, s36, 1024
buffer_load_dwordx4 v2, s[8:11], s36 offen sc1 lds
v_mfma_f32_16x16x32_bf16 v[120:123], v[52:55], v[64:67], v[120:123]
v_mfma_f32_16x16x32_bf16 v[140:143], v[52:55], v[68:71], v[140:143]
s_add_u32 m0, s29, 65536
s_add_u32 s36, s36, 1024
buffer_load_dwordx4 v2, s[8:11], s36 offen sc1 lds
s_waitcnt vmcnt(14)
s_waitcnt lgkmcnt(4)
v_mfma_f32_16x16x32_bf16 v[104:107], v[16:19], v[72:75], v[104:107]
ds_read_b128 v[36:39], v3 offset:5120
v_mfma_f32_16x16x32_bf16 v[124:127], v[16:19], v[76:79], v[124:127]
ds_read_b128 v[40:43], v3 offset:6144
s_add_u32 s37, s30, s63
s_add_u32 s63, s63, 4096
s_cmp_ge_u32 s63, 49152
s_cselect_b32 s63, 0, s63
s_add_u32 s38, s37, 0
buffer_load_dwordx4 v[56:59], v2, s[12:15], s38 offen sc1
s_waitcnt lgkmcnt(5)
v_mfma_f32_16x16x32_bf16 v[108:111], v[20:23], v[72:75], v[108:111]
ds_read_b128 v[44:47], v3 offset:7168
v_mfma_f32_16x16x32_bf16 v[128:131], v[20:23], v[76:79], v[128:131]
ds_read_b128 v[48:51], v3 offset:8192
s_add_u32 s38, s37, 49152
buffer_load_dwordx4 v[60:63], v2, s[12:15], s38 offen sc1
s_waitcnt lgkmcnt(6)
v_mfma_f32_16x16x32_bf16 v[112:115], v[24:27], v[72:75], v[112:115]
ds_read_b128 v[52:55], v3 offset:9216
v_mfma_f32_16x16x32_bf16 v[132:135], v[24:27], v[76:79], v[132:135]
s_add_u32 s38, s37, 1024
buffer_load_dwordx4 v[64:67], v2, s[12:15], s38 offen sc1
s_waitcnt lgkmcnt(6)
v_mfma_f32_16x16x32_bf16 v[116:119], v[28:31], v[72:75], v[116:119]
v_mfma_f32_16x16x32_bf16 v[136:139], v[28:31], v[76:79], v[136:139]
s_add_u32 s38, s37, 50176
buffer_load_dwordx4 v[68:71], v2, s[12:15], s38 offen sc1
s_waitcnt lgkmcnt(5)
v_mfma_f32_16x16x32_bf16 v[120:123], v[32:35], v[72:75], v[120:123]
v_mfma_f32_16x16x32_bf16 v[140:143], v[32:35], v[76:79], v[140:143]
s_waitcnt lgkmcnt(0)
s_barrier
v_mfma_f32_16x16x32_bf16 v[104:107], v[36:39], v[80:83], v[104:107]
ds_read_b128 v[16:19], v3 offset:20480
v_mfma_f32_16x16x32_bf16 v[124:127], v[36:39], v[84:87], v[124:127]
ds_read_b128 v[20:23], v3 offset:21504
s_add_u32 s36, s28, s62
s_add_u32 s62, s62, 20480
s_cmp_ge_u32 s62, 245760
s_cselect_b32 s62, 0, s62
s_add_u32 m0, s29, 0
s_nop 0
buffer_load_dwordx4 v2, s[8:11], s36 offen sc1 lds
v_mfma_f32_16x16x32_bf16 v[108:111], v[40:43], v[80:83], v[108:111]
ds_read_b128 v[24:27], v3 offset:22528
v_mfma_f32_16x16x32_bf16 v[128:131], v[40:43], v[84:87], v[128:131]
ds_read_b128 v[28:31], v3 offset:23552
s_add_u32 m0, s29, 1024
s_add_u32 s36, s36, 1024
buffer_load_dwordx4 v2, s[8:11], s36 offen sc1 lds
v_mfma_f32_16x16x32_bf16 v[112:115], v[44:47], v[80:83], v[112:115]
ds_read_b128 v[32:35], v3 offset:24576
v_mfma_f32_16x16x32_bf16 v[132:135], v[44:47], v[84:87], v[132:135]
s_add_u32 m0, s29, 2048
s_add_u32 s36, s36, 1024
buffer_load_dwordx4 v2, s[8:11], s36 offen sc1 lds
v_mfma_f32_16x16x32_bf16 v[116:119], v[48:51], v[80:83], v[116:119]
v_mfma_f32_16x16x32_bf16 v[136:139], v[48:51], v[84:87], v[136:139]
s_add_u32 m0, s29, 3072
s_add_u32 s36, s36, 1024
buffer_load_dwordx4 v2, s[8:11], s36 offen sc1 lds
v_mfma_f32_16x16x32_bf16 v[120:123], v[52:55], v[80:83], v[120:123]
v_mfma_f32_16x16x32_bf16 v[140:143], v[52:55], v[84:87], v[140:143]
s_add_u32 m0, s29, 4096
s_add_u32 s36, s36, 1024
buffer_load_dwordx4 v2, s[8:11], s36 offen sc1 lds
s_waitcnt vmcnt(14)
s_waitcnt lgkmcnt(4)
v_mfma_f32_16x16x32_bf16 v[104:107], v[16:19], v[88:91], v[104:107]
ds_read_b128 v[36:39], v3 offset:25600
v_mfma_f32_16x16x32_bf16 v[124:127], v[16:19], v[92:95], v[124:127]
ds_read_b128 v[40:43], v3 offset:26624
s_add_u32 s37, s30, s63
s_add_u32 s63, s63, 4096
s_cmp_ge_u32 s63, 49152
s_cselect_b32 s63, 0, s63
s_add_u32 s38, s37, 0
buffer_load_dwordx4 v[72:75], v2, s[12:15], s38 offen sc1
s_waitcnt lgkmcnt(5)
v_mfma_f32_16x16x32_bf16 v[108:111], v[20:23], v[88:91], v[108:111]
ds_read_b128 v[44:47], v3 offset:27648
v_mfma_f32_16x16x32_bf16 v[128:131], v[20:23], v[92:95], v[128:131]
ds_read_b128 v[48:51], v3 offset:28672
s_add_u32 s38, s37, 49152
buffer_load_dwordx4 v[76:79], v2, s[12:15], s38 offen sc1
s_waitcnt lgkmcnt(6)
v_mfma_f32_16x16x32_bf16 v[112:115], v[24:27], v[88:91], v[112:115]
ds_read_b128 v[52:55], v3 offset:29696
v_mfma_f32_16x16x32_bf16 v[132:135], v[24:27], v[92:95], v[132:135]
s_add_u32 s38, s37, 1024
buffer_load_dwordx4 v[80:83], v2, s[12:15], s38 offen sc1
s_waitcnt lgkmcnt(6)
v_mfma_f32_16x16x32_bf16 v[116:119], v[28:31], v[88:91], v[116:119]
v_mfma_f32_16x16x32_bf16 v[136:139], v[28:31], v[92:95], v[136:139]
s_add_u32 s38, s37, 50176
buffer_load_dwordx4 v[84:87], v2, s[12:15], s38 offen sc1
s_waitcnt lgkmcnt(5)
v_mfma_f32_16x16x32_bf16 v[120:123], v[32:35], v[88:91], v[120:123]
v_mfma_f32_16x16x32_bf16 v[140:143], v[32:35], v[92:95], v[140:143]
s_waitcnt lgkmcnt(0)
s_barrier
v_mfma_f32_16x16x32_bf16 v[104:107], v[36:39], v[96:99], v[104:107]
ds_read_b128 v[16:19], v15 offset:0
v_mfma_f32_16x16x32_bf16 v[124:127], v[36:39], v[100:103], v[124:127]
ds_read_b128 v[20:23], v15 offset:1024
s_add_u32 s36, s28, s62
s_add_u32 s62, s62, 20480
s_cmp_ge_u32 s62, 245760
s_cselect_b32 s62, 0, s62
s_add_u32 m0, s29, 20480
s_nop 0
buffer_load_dwordx4 v2, s[8:11], s36 offen sc1 lds
v_mfma_f32_16x16x32_bf16 v[108:111], v[40:43], v[96:99], v[108:111]
ds_read_b128 v[24:27], v15 offset:2048
v_mfma_f32_16x16x32_bf16 v[128:131], v[40:43], v[100:103], v[128:131]
ds_read_b128 v[28:31], v15 offset:3072
s_add_u32 m0, s29, 21504
s_add_u32 s36, s36, 1024
buffer_load_dwordx4 v2, s[8:11], s36 offen sc1 lds
v_mfma_f32_16x16x32_bf16 v[112:115], v[44:47], v[96:99], v[112:115]
ds_read_b128 v[32:35], v15 offset:4096
v_mfma_f32_16x16x32_bf16 v[132:135], v[44:47], v[100:103], v[132:135]
s_add_u32 m0, s29, 22528
s_add_u32 s36, s36, 1024
buffer_load_dwordx4 v2, s[8:11], s36 offen sc1 lds
v_mfma_f32_16x16x32_bf16 v[116:119], v[48:51], v[96:99], v[116:119]
v_mfma_f32_16x16x32_bf16 v[136:139], v[48:51], v[100:103], v[136:139]
s_add_u32 m0, s29, 23552
s_add_u32 s36, s36, 1024
buffer_load_dwordx4 v2, s[8:11], s36 offen sc1 lds
v_mfma_f32_16x16x32_bf16 v[120:123], v[52:55], v[96:99], v[120:123]
v_mfma_f32_16x16x32_bf16 v[140:143], v[52:55], v[100:103], v[140:143]
s_add_u32 m0, s29, 24576
s_add_u32 s36, s36, 1024
buffer_load_dwordx4 v2, s[8:11], s36 offen sc1 lds
s_waitcnt vmcnt(14)
s_waitcnt lgkmcnt(4)
v_mfma_f32_16x16x32_bf16 v[104:107], v[16:19], v[56:59], v[104:107]
ds_read_b128 v[36:39], v15 offset:5120
v_mfma_f32_16x16x32_bf16 v[124:127], v[16:19], v[60:63], v[124:127]
ds_read_b128 v[40:43], v15 offset:6144
s_add_u32 s37, s30, s63
s_add_u32 s63, s63, 4096
s_cmp_ge_u32 s63, 49152
s_cselect_b32 s63, 0, s63
s_add_u32 s38, s37, 0
buffer_load_dwordx4 v[88:91], v2, s[12:15], s38 offen sc1
s_waitcnt lgkmcnt(5)
v_mfma_f32_16x16x32_bf16 v[108:111], v[20:23], v[56:59], v[108:111]
ds_read_b128 v[44:47], v15 offset:7168
v_mfma_f32_16x16x32_bf16 v[128:131], v[20:23], v[60:63], v[128:131]
ds_read_b128 v[48:51], v15 offset:8192
s_add_u32 s38, s37, 49152
buffer_load_dwordx4 v[92:95], v2, s[12:15], s38 offen sc1
s_waitcnt lgkmcnt(6)
v_mfma_f32_16x16x32_bf16 v[112:115], v[24:27], v[56:59], v[112:115]
ds_read_b128 v[52:55], v15 offset:9216
v_mfma_f32_16x16x32_bf16 v[132:135], v[24:27], v[60:63], v[132:135]
s_add_u32 s38, s37, 1024
buffer_load_dwordx4 v[96:99], v2, s[12:15], s38 offen sc1
s_waitcnt lgkmcnt(6)
v_mfma_f32_16x16x32_bf16 v[116:119], v[28:31], v[56:59], v[116:119]
v_mfma_f32_16x16x32_bf16 v[136:139], v[28:31], v[60:63], v[136:139]
s_add_u32 s38, s37, 50176
buffer_load_dwordx4 v[100:103], v2, s[12:15], s38 offen sc1
s_waitcnt lgkmcnt(5)
v_mfma_f32_16x16x32_bf16 v[120:123], v[32:35], v[56:59], v[120:123]
v_mfma_f32_16x16x32_bf16 v[140:143], v[32:35], v[60:63], v[140:143]
s_waitcnt lgkmcnt(0)
s_barrier
v_mfma_f32_16x16x32_bf16 v[104:107], v[36:39], v[64:67], v[104:107]
ds_read_b128 v[16:19], v15 offset:20480
v_mfma_f32_16x16x32_bf16 v[124:127], v[36:39], v[68:71], v[124:127]
ds_read_b128 v[20:23], v15 offset:21504
s_add_u32 s36, s28, s62
s_add_u32 s62, s62, 20480
s_cmp_ge_u32 s62, 245760
s_cselect_b32 s62, 0, s62
s_add_u32 m0, s29, 40960
s_nop 0
buffer_load_dwordx4 v2, s[8:11], s36 offen sc1 lds
v_mfma_f32_16x16x32_bf16 v[108:111], v[40:43], v[64:67], v[108:111]
ds_read_b128 v[24:27], v15 offset:22528
v_mfma_f32_16x16x32_bf16 v[128:131], v[40:43], v[68:71], v[128:131]
ds_read_b128 v[28:31], v15 offset:23552
s_add_u32 m0, s29, 41984
s_add_u32 s36, s36, 1024
buffer_load_dwordx4 v2, s[8:11], s36 offen sc1 lds
v_mfma_f32_16x16x32_bf16 v[112:115], v[44:47], v[64:67], v[112:115]
ds_read_b128 v[32:35], v15 offset:24576
v_mfma_f32_16x16x32_bf16 v[132:135], v[44:47], v[68:71], v[132:135]
s_add_u32 m0, s29, 43008
s_add_u32 s36, s36, 1024
buffer_load_dwordx4 v2, s[8:11], s36 offen sc1 lds
v_mfma_f32_16x16x32_bf16 v[116:119], v[48:51], v[64:67], v[116:119]
v_mfma_f32_16x16x32_bf16 v[136:139], v[48:51], v[68:71], v[136:139]
s_add_u32 m0, s29, 44032
s_add_u32 s36, s36, 1024
buffer_load_dwordx4 v2, s[8:11], s36 offen sc1 lds
v_mfma_f32_16x16x32_bf16 v[120:123], v[52:55], v[64:67], v[120:123]
v_mfma_f32_16x16x32_bf16 v[140:143], v[52:55], v[68:71], v[140:143]
s_add_u32 m0, s29, 45056
s_add_u32 s36, s36, 1024
buffer_load_dwordx4 v2, s[8:11], s36 offen sc1 lds
s_waitcnt vmcnt(14)
s_waitcnt lgkmcnt(4)
v_mfma_f32_16x16x32_bf16 v[104:107], v[16:19], v[72:75], v[104:107]
ds_read_b128 v[36:39], v15 offset:25600
v_mfma_f32_16x16x32_bf16 v[124:127], v[16:19], v[76:79], v[124:127]
ds_read_b128 v[40:43], v15 offset:26624
s_add_u32 s37, s30, s63
s_add_u32 s63, s63, 4096
s_cmp_ge_u32 s63, 49152
s_cselect_b32 s63, 0, s63
s_add_u32 s38, s37, 0
buffer_load_dwordx4 v[56:59], v2, s[12:15], s38 offen sc1
s_waitcnt lgkmcnt(5)
v_mfma_f32_16x16x32_bf16 v[108:111], v[20:23], v[72:75], v[108:111]
ds_read_b128 v[44:47], v15 offset:27648
v_mfma_f32_16x16x32_bf16 v[128:131], v[20:23], v[76:79], v[128:131]
ds_read_b128 v[48:51], v15 offset:28672
s_add_u32 s38, s37, 49152
buffer_load_dwordx4 v[60:63], v2, s[12:15], s38 offen sc1
s_waitcnt lgkmcnt(6)
v_mfma_f32_16x16x32_bf16 v[112:115], v[24:27], v[72:75], v[112:115]
ds_read_b128 v[52:55], v15 offset:29696
v_mfma_f32_16x16x32_bf16 v[132:135], v[24:27], v[76:79], v[132:135]
s_add_u32 s38, s37, 1024
buffer_load_dwordx4 v[64:67], v2, s[12:15], s38 offen sc1
s_waitcnt lgkmcnt(6)
v_mfma_f32_16x16x32_bf16 v[116:119], v[28:31], v[72:75], v[116:119]
v_mfma_f32_16x16x32_bf16 v[136:139], v[28:31], v[76:79], v[136:139]
s_add_u32 s38, s37, 50176
buffer_load_dwordx4 v[68:71], v2, s[12:15], s38 offen sc1
s_waitcnt lgkmcnt(5)
v_mfma_f32_16x16x32_bf16 v[120:123], v[32:35], v[72:75], v[120:123]
v_mfma_f32_16x16x32_bf16 v[140:143], v[32:35], v[76:79], v[140:143]
s_waitcnt lgkmcnt(0)
s_barrier
v_mfma_f32_16x16x32_bf16 v[104:107], v[36:39], v[80:83], v[104:107]
ds_read_b128 v[16:19], v3 offset:0
v_mfma_f32_16x16x32_bf16 v[124:127], v[36:39], v[84:87], v[124:127]
ds_read_b128 v[20:23], v3 offset:1024
s_add_u32 s36, s28, s62
s_add_u32 s62, s62, 20480
s_cmp_ge_u32 s62, 245760
s_cselect_b32 s62, 0, s62
s_add_u32 m0, s29, 61440
s_nop 0
buffer_load_dwordx4 v2, s[8:11], s36 offen sc1 lds
v_mfma_f32_16x16x32_bf16 v[108:111], v[40:43], v[80:83], v[108:111]
ds_read_b128 v[24:27], v3 offset:2048
v_mfma_f32_16x16x32_bf16 v[128:131], v[40:43], v[84:87], v[128:131]
ds_read_b128 v[28:31], v3 offset:3072
s_add_u32 m0, s29, 62464
s_add_u32 s36, s36, 1024
buffer_load_dwordx4 v2, s[8:11], s36 offen sc1 lds
v_mfma_f32_16x16x32_bf16 v[112:115], v[44:47], v[80:83], v[112:115]
ds_read_b128 v[32:35], v3 offset:4096
v_mfma_f32_16x16x32_bf16 v[132:135], v[44:47], v[84:87], v[132:135]
s_add_u32 m0, s29, 63488
s_add_u32 s36, s36, 1024
buffer_load_dwordx4 v2, s[8:11], s36 offen sc1 lds
v_mfma_f32_16x16x32_bf16 v[116:119], v[48:51], v[80:83], v[116:119]
v_mfma_f32_16x16x32_bf16 v[136:139], v[48:51], v[84:87], v[136:139]
s_add_u32 m0, s29, 64512
s_add_u32 s36, s36, 1024
buffer_load_dwordx4 v2, s[8:11], s36 offen sc1 lds
v_mfma_f32_16x16x32_bf16 v[120:123], v[52:55], v[80:83], v[120:123]
v_mfma_f32_16x16x32_bf16 v[140:143], v[52:55], v[84:87], v[140:143]
s_add_u32 m0, s29, 65536
s_add_u32 s36, s36, 1024
buffer_load_dwordx4 v2, s[8:11], s36 offen sc1 lds
s_cmp_eq_u32 s4, 0
s_cbranch_scc0 L_w0a_17
v_lshlrev_b32 v248, 3, v1
s_mov_b32 exec_lo, 0xffffffff
s_mov_b32 exec_hi, 0xff
buffer_load_dwordx2 v[252:253], v248, s[20:23], s48 offen sc1
s_mov_b64 exec, -1
v_lshlrev_b32 v249, 2, v1
s_mov_b32 exec_lo, 0xf
s_mov_b32 exec_hi, 0x0
buffer_load_dword v254, v249, s[20:23], s49 offen sc1
s_mov_b64 exec, -1
L_w0a_17:
s_waitcnt vmcnt(14)
s_waitcnt lgkmcnt(4)
v_mfma_f32_16x16x32_bf16 v[104:107], v[16:19], v[88:91], v[104:107]
ds_read_b128 v[36:39], v3 offset:5120
v_mfma_f32_16x16x32_bf16 v[124:127], v[16:19], v[92:95], v[124:127]
ds_read_b128 v[40:43], v3 offset:6144
s_add_u32 s37, s30, s63
s_add_u32 s63, s63, 4096
s_cmp_ge_u32 s63, 49152
s_cselect_b32 s63, 0, s63
s_add_u32 s38, s37, 0
buffer_load_dwordx4 v[72:75], v2, s[12:15], s38 offen sc1
s_waitcnt lgkmcnt(5)
v_mfma_f32_16x16x32_bf16 v[108:111], v[20:23], v[88:91], v[108:111]
ds_read_b128 v[44:47], v3 offset:7168
v_mfma_f32_16x16x32_bf16 v[128:131], v[20:23], v[92:95], v[128:131]
ds_read_b128 v[48:51], v3 offset:8192
s_add_u32 s38, s37, 49152
buffer_load_dwordx4 v[76:79], v2, s[12:15], s38 offen sc1
s_waitcnt lgkmcnt(6)
v_mfma_f32_16x16x32_bf16 v[112:115], v[24:27], v[88:91], v[112:115]
ds_read_b128 v[52:55], v3 offset:9216
v_mfma_f32_16x16x32_bf16 v[132:135], v[24:27], v[92:95], v[132:135]
s_add_u32 s38, s37, 1024
buffer_load_dwordx4 v[80:83], v2, s[12:15], s38 offen sc1
s_waitcnt lgkmcnt(6)
v_mfma_f32_16x16x32_bf16 v[116:119], v[28:31], v[88:91], v[116:119]
v_mfma_f32_16x16x32_bf16 v[136:139], v[28:31], v[92:95], v[136:139]
s_add_u32 s38, s37, 50176
buffer_load_dwordx4 v[84:87], v2, s[12:15], s38 offen sc1
s_waitcnt lgkmcnt(5)
v_mfma_f32_16x16x32_bf16 v[120:123], v[32:35], v[88:91], v[120:123]
v_mfma_f32_16x16x32_bf16 v[140:143], v[32:35], v[92:95], v[140:143]
s_waitcnt lgkmcnt(0)
s_barrier
v_mfma_f32_16x16x32_bf16 v[104:107], v[36:39], v[96:99], v[104:107]
ds_read_b128 v[16:19], v3 offset:20480
v_mfma_f32_16x16x32_bf16 v[124:127], v[36:39], v[100:103], v[124:127]
ds_read_b128 v[20:23], v3 offset:21504
v_mfma_f32_16x16x32_bf16 v[108:111], v[40:43], v[96:99], v[108:111]
ds_read_b128 v[24:27], v3 offset:22528
v_mfma_f32_16x16x32_bf16 v[128:131], v[40:43], v[100:103], v[128:131]
ds_read_b128 v[28:31], v3 offset:23552
v_mfma_f32_16x16x32_bf16 v[112:115], v[44:47], v[96:99], v[112:115]
ds_read_b128 v[32:35], v3 offset:24576
v_mfma_f32_16x16x32_bf16 v[132:135], v[44:47], v[100:103], v[132:135]
v_mfma_f32_16x16x32_bf16 v[116:119], v[48:51], v[96:99], v[116:119]
v_mfma_f32_16x16x32_bf16 v[136:139], v[48:51], v[100:103], v[136:139]
v_mfma_f32_16x16x32_bf16 v[120:123], v[52:55], v[96:99], v[120:123]
v_mfma_f32_16x16x32_bf16 v[140:143], v[52:55], v[100:103], v[140:143]
s_waitcnt vmcnt(9)
s_waitcnt lgkmcnt(4)
v_mfma_f32_16x16x32_bf16 v[104:107], v[16:19], v[56:59], v[104:107]
ds_read_b128 v[36:39], v3 offset:25600
v_mfma_f32_16x16x32_bf16 v[124:127], v[16:19], v[60:63], v[124:127]
ds_read_b128 v[40:43], v3 offset:26624
s_add_u32 s37, s30, s63
s_add_u32 s63, s63, 4096
s_cmp_ge_u32 s63, 49152
s_cselect_b32 s63, 0, s63
s_add_u32 s38, s37, 0
buffer_load_dwordx4 v[88:91], v2, s[12:15], s38 offen sc1
s_waitcnt lgkmcnt(5)
v_mfma_f32_16x16x32_bf16 v[108:111], v[20:23], v[56:59], v[108:111]
ds_read_b128 v[44:47], v3 offset:27648
v_mfma_f32_16x16x32_bf16 v[128:131], v[20:23], v[60:63], v[128:131]
ds_read_b128 v[48:51], v3 offset:28672
s_add_u32 s38, s37, 49152
buffer_load_dwordx4 v[92:95], v2, s[12:15], s38 offen sc1
s_waitcnt lgkmcnt(6)
v_mfma_f32_16x16x32_bf16 v[112:115], v[24:27], v[56:59], v[112:115]
ds_read_b128 v[52:55], v3 offset:29696
v_mfma_f32_16x16x32_bf16 v[132:135], v[24:27], v[60:63], v[132:135]
s_add_u32 s38, s37, 1024
buffer_load_dwordx4 v[96:99], v2, s[12:15], s38 offen sc1
s_waitcnt lgkmcnt(6)
v_mfma_f32_16x16x32_bf16 v[116:119], v[28:31], v[56:59], v[116:119]
v_mfma_f32_16x16x32_bf16 v[136:139], v[28:31], v[60:63], v[136:139]
s_add_u32 s38, s37, 50176
buffer_load_dwordx4 v[100:103], v2, s[12:15], s38 offen sc1
s_waitcnt lgkmcnt(5)
v_mfma_f32_16x16x32_bf16 v[120:123], v[32:35], v[56:59], v[120:123]
v_mfma_f32_16x16x32_bf16 v[140:143], v[32:35], v[60:63], v[140:143]
s_waitcnt lgkmcnt(0)
s_cmp_eq_u32 s4, 0
s_cbranch_scc0 L_w0p_18
s_waitcnt vmcnt(8)
s_mov_b32 exec_lo, 0xffffffff
s_mov_b32 exec_hi, 0xff
v_cmp_ne_u32 vcc, s58, v252
v_cmp_ne_u32 s[56:57], s58, v253
s_nop 1
s_or_b64 vcc, vcc, s[56:57]
s_mov_b64 exec, -1
s_cmp_eq_u64 vcc, 0
s_cbranch_scc1 L_flags_ok_19
v_lshlrev_b32 v248, 3, v1
s_mov_b32 s59, 0
s_mov_b32 exec_lo, 0xffffffff
s_mov_b32 exec_hi, 0xff
L_poll_20:
buffer_load_dwordx2 v[250:251], v248, s[20:23], s48 offen sc1
s_waitcnt vmcnt(0)
v_cmp_ne_u32 vcc, s58, v250
v_cmp_ne_u32 s[56:57], s58, v251
s_nop 1
s_or_b64 vcc, vcc, s[56:57]
s_cmp_eq_u64 vcc, 0
s_cbranch_scc1 L_polled_21
s_add_u32 s59, s59, 1
s_cmp_lt_u32 s59, 16384
s_cbranch_scc0 L_to_22
s_sleep 4
s_branch L_poll_20
L_to_22:
L_polled_21:
s_mov_b64 exec, -1
L_flags_ok_19:
s_waitcnt vmcnt(8)
s_mov_b32 exec_lo, 0xf
s_mov_b32 exec_hi, 0x0
v_cmp_ne_u32 vcc, s58, v254
s_mov_b64 exec, -1
s_cmp_eq_u64 vcc, 0
s_cbranch_scc1 L_flags_ok_23
v_lshlrev_b32 v248, 2, v1
s_mov_b32 s59, 0
s_mov_b32 exec_lo, 0xf
s_mov_b32 exec_hi, 0x0
L_poll_24:
buffer_load_dword v250, v248, s[20:23], s49 offen sc1
s_waitcnt vmcnt(0)
v_cmp_ne_u32 vcc, s58, v250
s_nop 1
s_cmp_eq_u64 vcc, 0
s_cbranch_scc1 L_polled_25
s_add_u32 s59, s59, 1
s_cmp_lt_u32 s59, 16384
s_cbranch_scc0 L_to_26
s_sleep 4
s_branch L_poll_24
L_to_26:
L_polled_25:
s_mov_b64 exec, -1
L_flags_ok_23:
L_w0p_18:
s_barrier
v_mfma_f32_16x16x32_bf16 v[104:107], v[36:39], v[64:67], v[104:107]
ds_read_b128 v[16:19], v15 offset:0
s_add_u32 s16, s32, 0xf90000
s_addc_u32 s17, s33, 0
s_mov_b32 s18, 0x280000
s_mov_b32 s19, 0x20000
s_add_u32 s52, s32, 0xf88000
s_addc_u32 s53, s33, 0
s_mov_b32 s54, 0x2000
s_mov_b32 s55, 0x20000
buffer_load_dword v164, v11, s[52:55], 0 offen sc1
v_mfma_f32_16x16x32_bf16 v[124:127], v[36:39], v[68:71], v[124:127]
ds_read_b128 v[20:23], v15 offset:1024
s_mov_b32 s39, 0
buffer_load_ushort v144, v9, s[16:19], s39 offen sc1
v_mfma_f32_16x16x32_bf16 v[108:111], v[40:43], v[64:67], v[108:111]
ds_read_b128 v[24:27], v15 offset:2048
s_mov_b32 s39, 4096
buffer_load_ushort v145, v9, s[16:19], s39 offen sc1
v_mfma_f32_16x16x32_bf16 v[128:131], v[40:43], v[68:71], v[128:131]
ds_read_b128 v[28:31], v15 offset:3072
s_mov_b32 s39, 8192
buffer_load_ushort v146, v9, s[16:19], s39 offen sc1
v_mfma_f32_16x16x32_bf16 v[112:115], v[44:47], v[64:67], v[112:115]
ds_read_b128 v[32:35], v15 offset:4096
s_mov_b32 s39, 12288
buffer_load_ushort v147, v9, s[16:19], s39 offen sc1
v_mfma_f32_16x16x32_bf16 v[132:135], v[44:47], v[68:71], v[132:135]
s_mov_b32 s39, 65536
buffer_load_ushort v148, v9, s[16:19], s39 offen sc1
v_mfma_f32_16x16x32_bf16 v[116:119], v[48:51], v[64:67], v[116:119]
s_mov_b32 s39, 69632
buffer_load_ushort v149, v9, s[16:19], s39 offen sc1
v_mfma_f32_16x16x32_bf16 v[136:139], v[48:51], v[68:71], v[136:139]
s_mov_b32 s39, 73728
buffer_load_ushort v150, v9, s[16:19], s39 offen sc1
v_mfma_f32_16x16x32_bf16 v[120:123], v[52:55], v[64:67], v[120:123]
s_mov_b32 s39, 77824
buffer_load_ushort v151, v9, s[16:19], s39 offen sc1
v_mfma_f32_16x16x32_bf16 v[140:143], v[52:55], v[68:71], v[140:143]
s_mov_b32 s39, 131072
buffer_load_ushort v152, v9, s[16:19], s39 offen sc1
s_waitcnt vmcnt(14)
s_waitcnt lgkmcnt(4)
v_mfma_f32_16x16x32_bf16 v[104:107], v[16:19], v[72:75], v[104:107]
ds_read_b128 v[36:39], v15 offset:5120
s_mov_b32 s39, 135168
buffer_load_ushort v153, v9, s[16:19], s39 offen sc1
v_mfma_f32_16x16x32_bf16 v[124:127], v[16:19], v[76:79], v[124:127]
ds_read_b128 v[40:43], v15 offset:6144
s_mov_b32 s39, 139264
buffer_load_ushort v154, v9, s[16:19], s39 offen sc1
s_waitcnt lgkmcnt(5)
v_mfma_f32_16x16x32_bf16 v[108:111], v[20:23], v[72:75], v[108:111]
ds_read_b128 v[44:47], v15 offset:7168
v_mfma_f32_16x16x32_bf16 v[128:131], v[20:23], v[76:79], v[128:131]
ds_read_b128 v[48:51], v15 offset:8192
s_mov_b32 s39, 143360
buffer_load_ushort v155, v9, s[16:19], s39 offen sc1
s_waitcnt lgkmcnt(6)
v_mfma_f32_16x16x32_bf16 v[112:115], v[24:27], v[72:75], v[112:115]
ds_read_b128 v[52:55], v15 offset:9216
v_mfma_f32_16x16x32_bf16 v[132:135], v[24:27], v[76:79], v[132:135]
s_mov_b32 s39, 196608
buffer_load_ushort v156, v9, s[16:19], s39 offen sc1
s_waitcnt lgkmcnt(6)
v_mfma_f32_16x16x32_bf16 v[116:119], v[28:31], v[72:75], v[116:119]
v_mfma_f32_16x16x32_bf16 v[136:139], v[28:31], v[76:79], v[136:139]
s_mov_b32 s39, 200704
buffer_load_ushort v157, v9, s[16:19], s39 offen sc1
s_waitcnt lgkmcnt(5)
v_mfma_f32_16x16x32_bf16 v[120:123], v[32:35], v[72:75], v[120:123]
v_mfma_f32_16x16x32_bf16 v[140:143], v[32:35], v[76:79], v[140:143]
s_mov_b32 s39, 204800
buffer_load_ushort v158, v9, s[16:19], s39 offen sc1
s_waitcnt lgkmcnt(0)
s_barrier
v_mfma_f32_16x16x32_bf16 v[104:107], v[36:39], v[80:83], v[104:107]
ds_read_b128 v[16:19], v15 offset:20480
v_mfma_f32_16x16x32_bf16 v[124:127], v[36:39], v[84:87], v[124:127]
ds_read_b128 v[20:23], v15 offset:21504
s_mov_b32 s39, 208896
buffer_load_ushort v159, v9, s[16:19], s39 offen sc1
v_mfma_f32_16x16x32_bf16 v[108:111], v[40:43], v[80:83], v[108:111]
ds_read_b128 v[24:27], v15 offset:22528
v_mfma_f32_16x16x32_bf16 v[128:131], v[40:43], v[84:87], v[128:131]
ds_read_b128 v[28:31], v15 offset:23552
s_mov_b32 s39, 262144
buffer_load_ushort v160, v9, s[16:19], s39 offen sc1
v_mfma_f32_16x16x32_bf16 v[112:115], v[44:47], v[80:83], v[112:115]
ds_read_b128 v[32:35], v15 offset:24576
v_mfma_f32_16x16x32_bf16 v[132:135], v[44:47], v[84:87], v[132:135]
s_mov_b32 s39, 266240
buffer_load_ushort v161, v9, s[16:19], s39 offen sc1
v_mfma_f32_16x16x32_bf16 v[116:119], v[48:51], v[80:83], v[116:119]
v_mfma_f32_16x16x32_bf16 v[136:139], v[48:51], v[84:87], v[136:139]
s_mov_b32 s39, 270336
buffer_load_ushort v162, v9, s[16:19], s39 offen sc1
v_mfma_f32_16x16x32_bf16 v[120:123], v[52:55], v[80:83], v[120:123]
v_mfma_f32_16x16x32_bf16 v[140:143], v[52:55], v[84:87], v[140:143]
s_mov_b32 s39, 274432
buffer_load_ushort v163, v9, s[16:19], s39 offen sc1
s_waitcnt vmcnt(21)
s_waitcnt lgkmcnt(4)
v_mfma_f32_16x16x32_bf16 v[104:107], v[16:19], v[88:91], v[104:107]
ds_read_b128 v[36:39], v15 offset:25600
v_mfma_f32_16x16x32_bf16 v[124:127], v[16:19], v[92:95], v[124:127]
ds_read_b128 v[40:43], v15 offset:26624
s_waitcnt lgkmcnt(5)
v_mfma_f32_16x16x32_bf16 v[108:111], v[20:23], v[88:91], v[108:111]
ds_read_b128 v[44:47], v15 offset:27648
v_mfma_f32_16x16x32_bf16 v[128:131], v[20:23], v[92:95], v[128:131]
ds_read_b128 v[48:51], v15 offset:28672
s_waitcnt lgkmcnt(6)
v_mfma_f32_16x16x32_bf16 v[112:115], v[24:27], v[88:91], v[112:115]
ds_read_b128 v[52:55], v15 offset:29696
v_mfma_f32_16x16x32_bf16 v[132:135], v[24:27], v[92:95], v[132:135]
s_waitcnt lgkmcnt(6)
v_mfma_f32_16x16x32_bf16 v[116:119], v[28:31], v[88:91], v[116:119]
v_mfma_f32_16x16x32_bf16 v[136:139], v[28:31], v[92:95], v[136:139]
s_waitcnt lgkmcnt(5)
v_mfma_f32_16x16x32_bf16 v[120:123], v[32:35], v[88:91], v[120:123]
v_mfma_f32_16x16x32_bf16 v[140:143], v[32:35], v[92:95], v[140:143]
s_waitcnt lgkmcnt(0)
v_mfma_f32_16x16x32_bf16 v[104:107], v[36:39], v[96:99], v[104:107]
v_mfma_f32_16x16x32_bf16 v[124:127], v[36:39], v[100:103], v[124:127]
v_mfma_f32_16x16x32_bf16 v[108:111], v[40:43], v[96:99], v[108:111]
v_mfma_f32_16x16x32_bf16 v[128:131], v[40:43], v[100:103], v[128:131]
v_mfma_f32_16x16x32_bf16 v[112:115], v[44:47], v[96:99], v[112:115]
v_mfma_f32_16x16x32_bf16 v[132:135], v[44:47], v[100:103], v[132:135]
v_mfma_f32_16x16x32_bf16 v[116:119], v[48:51], v[96:99], v[116:119]
v_mfma_f32_16x16x32_bf16 v[136:139], v[48:51], v[100:103], v[136:139]
v_mfma_f32_16x16x32_bf16 v[120:123], v[52:55], v[96:99], v[120:123]
v_mfma_f32_16x16x32_bf16 v[140:143], v[52:55], v[100:103], v[140:143]
s_lshl_b32 s36, s4, 13
v_add_u32 v4, s36, v2
s_xor_b32 s37, s4, 2
s_lshl_b32 s37, s37, 13
v_add_u32 v5, s37, v2
s_cmp_eq_u32 s27, 0
s_cbranch_scc1 L_f2_k0_27
s_nop 7
ds_write_b128 v4, v[104:107] offset:0
ds_write_b128 v4, v[108:111] offset:1024
ds_write_b128 v4, v[112:115] offset:2048
ds_write_b128 v4, v[116:119] offset:3072
ds_write_b128 v4, v[120:123] offset:4096
v_mov_b32 v104, v124
v_mov_b32 v105, v125
v_mov_b32 v106, v126
v_mov_b32 v107, v127
v_mov_b32 v108, v128
v_mov_b32 v109, v129
v_mov_b32 v110, v130
v_mov_b32 v111, v131
v_mov_b32 v112, v132
v_mov_b32 v113, v133
v_mov_b32 v114, v134
v_mov_b32 v115, v135
v_mov_b32 v116, v136
v_mov_b32 v117, v137
v_mov_b32 v118, v138
v_mov_b32 v119, v139
v_mov_b32 v120, v140
v_mov_b32 v121, v141
v_mov_b32 v122, v142
v_mov_b32 v123, v143
s_branch L_f2_join_28
L_f2_k0_27:
s_nop 7
ds_write_b128 v4, v[124:127] offset:0
ds_write_b128 v4, v[128:131] offset:1024
ds_write_b128 v4, v[132:135] offset:2048
ds_write_b128 v4, v[136:139] offset:3072
ds_write_b128 v4, v[140:143] offset:4096
L_f2_join_28:
s_waitcnt lgkmcnt(0)
s_barrier
ds_read_b128 v[16:19], v5 offset:0
ds_read_b128 v[20:23], v5 offset:1024
ds_read_b128 v[24:27], v5 offset:2048
ds_read_b128 v[28:31], v5 offset:3072
ds_read_b128 v[32:35], v5 offset:4096
s_waitcnt vmcnt(20)
v_sub_f32 v12, 1.0, v164
v_cvt_pk_bf16_f32 v12, v12, v12
v_lshlrev_b32 v12, 16, v12
s_mov_b32 s48, 0xffff0000
s_waitcnt lgkmcnt(0)
v_add_f32 v104, v104, v16
v_add_f32 v105, v105, v17
v_add_f32 v106, v106, v18
v_add_f32 v107, v107, v19
v_add_f32 v108, v108, v20
v_add_f32 v109, v109, v21
v_add_f32 v110, v110, v22
v_add_f32 v111, v111, v23
v_add_f32 v112, v112, v24
v_add_f32 v113, v113, v25
v_add_f32 v114, v114, v26
v_add_f32 v115, v115, v27
v_add_f32 v116, v116, v28
v_add_f32 v117, v117, v29
v_add_f32 v118, v118, v30
v_add_f32 v119, v119, v31
v_add_f32 v120, v120, v32
v_add_f32 v121, v121, v33
v_add_f32 v122, v122, v34
v_add_f32 v123, v123, v35
s_waitcnt vmcnt(16)
v_lshlrev_b32 v144, 16, v144
v_lshlrev_b32 v145, 16, v145
v_lshlrev_b32 v146, 16, v146
v_lshlrev_b32 v147, 16, v147
v_mul_f32 v144, v164, v144
v_mul_f32 v145, v164, v145
v_mul_f32 v146, v164, v146
v_mul_f32 v147, v164, v147
v_fma_f32 v144, v12, v104, v144
v_fma_f32 v145, v12, v105, v145
v_fma_f32 v146, v12, v106, v146
v_fma_f32 v147, v12, v107, v147
v_cvt_pk_bf16_f32 v56, v144, v145
v_cvt_pk_bf16_f32 v57, v146, v147
buffer_store_dwordx2 v[56:57], v10, s[44:47], 0 offen offset:0
s_waitcnt vmcnt(13)
v_lshlrev_b32 v148, 16, v148
v_lshlrev_b32 v149, 16, v149
v_lshlrev_b32 v150, 16, v150
v_lshlrev_b32 v151, 16, v151
v_mul_f32 v148, v164, v148
v_mul_f32 v149, v164, v149
v_mul_f32 v150, v164, v150
v_mul_f32 v151, v164, v151
v_fma_f32 v148, v12, v108, v148
v_fma_f32 v149, v12, v109, v149
v_fma_f32 v150, v12, v110, v150
v_fma_f32 v151, v12, v111, v151
v_cvt_pk_bf16_f32 v64, v148, v149
v_cvt_pk_bf16_f32 v65, v150, v151
buffer_store_dwordx2 v[64:65], v10, s[44:47], 0 offen offset:32
s_waitcnt vmcnt(10)
v_lshlrev_b32 v152, 16, v152
v_lshlrev_b32 v153, 16, v153
v_lshlrev_b32 v154, 16, v154
v_lshlrev_b32 v155, 16, v155
v_mul_f32 v152, v164, v152
v_mul_f32 v153, v164, v153
v_mul_f32 v154, v164, v154
v_mul_f32 v155, v164, v155
v_fma_f32 v152, v12, v112, v152
v_fma_f32 v153, v12, v113, v153
v_fma_f32 v154, v12, v114, v154
v_fma_f32 v155, v12, v115, v155
v_cvt_pk_bf16_f32 v56, v152, v153
v_cvt_pk_bf16_f32 v57, v154, v155
buffer_store_dwordx2 v[56:57], v10, s[44:47], 0 offen offset:64
s_waitcnt vmcnt(7)
v_lshlrev_b32 v156, 16, v156
v_lshlrev_b32 v157, 16, v157
v_lshlrev_b32 v158, 16, v158
v_lshlrev_b32 v159, 16, v159
v_mul_f32 v156, v164, v156
v_mul_f32 v157, v164, v157
v_mul_f32 v158, v164, v158
v_mul_f32 v159, v164, v159
v_fma_f32 v156, v12, v116, v156
v_fma_f32 v157, v12, v117, v157
v_fma_f32 v158, v12, v118, v158
v_fma_f32 v159, v12, v119, v159
v_cvt_pk_bf16_f32 v64, v156, v157
v_cvt_pk_bf16_f32 v65, v158, v159
buffer_store_dwordx2 v[64:65], v10, s[44:47], 0 offen offset:96
s_waitcnt vmcnt(4)
v_lshlrev_b32 v160, 16, v160
v_lshlrev_b32 v161, 16, v161
v_lshlrev_b32 v162, 16, v162
v_lshlrev_b32 v163, 16, v163
v_mul_f32 v160, v164, v160
v_mul_f32 v161, v164, v161
v_mul_f32 v162, v164, v162
v_mul_f32 v163, v164, v163
v_fma_f32 v160, v12, v120, v160
v_fma_f32 v161, v12, v121, v161
v_fma_f32 v162, v12, v122, v162
v_fma_f32 v163, v12, v123, v163
v_cvt_pk_bf16_f32 v56, v160, v161
v_cvt_pk_bf16_f32 v57, v162, v163
buffer_store_dwordx2 v[56:57], v10, s[44:47], 0 offen offset:128
s_endpgm
L_ssm:
v_and_b32 v1, 63, v0
s_lshl_b32 s40, s6, 3
s_add_u32 s40, s40, s5
s_cmp_ge_u32 s6, 16
s_cbranch_scc1 L_typeB
s_cmp_eq_u32 s4, 3
s_cbranch_scc1 L_taskA
s_mul_i32 s40, s40, 3
s_add_u32 s40, s40, s4
s_branch L_chan
L_typeB:
s_cmp_ge_u32 s4, 2
s_cbranch_scc1 L_taskB
s_sub_u32 s40, s40, 128
s_lshl_b32 s40, s40, 1
s_add_u32 s40, s40, s4
s_add_u32 s40, s40, 384
L_chan:
s_mul_i32 s43, s4, 23808
s_load_dwordx16 s[16:31], s[0:1], 8
s_load_dwordx2 s[32:33], s[0:1], 128
s_load_dwordx2 s[60:61], s[0:1], 120
s_mul_i32 s41, s40, 384
v_lshlrev_b32 v2, 1, v1
v_add_u32 v2, s41, v2
s_lshl_b32 s42, s40, 1
v_mov_b32 v4, s42
v_mov_b32 v250, 0
s_waitcnt lgkmcnt(0)
global_load_ushort v3, v4, s[28:29]
global_load_ushort v8, v2, s[16:17] offset:0 nt
global_load_ushort v9, v2, s[18:19] offset:0 nt
global_load_ushort v10, v2, s[20:21] offset:0 nt
global_load_ushort v11, v2, s[22:23] offset:0 nt
global_load_ushort v12, v2, s[24:25] offset:0 nt
global_load_ushort v13, v2, s[26:27] offset:0 nt
global_load_ushort v14, v2, s[16:17] offset:128 nt
global_load_ushort v15, v2, s[18:19] offset:128 nt
global_load_ushort v16, v2, s[20:21] offset:128 nt
global_load_ushort v17, v2, s[22:23] offset:128 nt
global_load_ushort v18, v2, s[24:25] offset:128 nt
global_load_ushort v19, v2, s[26:27] offset:128 nt
global_load_ushort v20, v2, s[16:17] offset:256 nt
global_load_ushort v21, v2, s[18:19] offset:256 nt
global_load_ushort v22, v2, s[20:21] offset:256 nt
global_load_ushort v23, v2, s[22:23] offset:256 nt
global_load_ushort v24, v2, s[24:25] offset:256 nt
global_load_ushort v25, v2, s[26:27] offset:256 nt
global_load_ushort v243, v4, s[30:31]
global_load_dword v251, v250, s[60:61] sc1
v_and_b32 v6, 31, v1
v_mul_u32_u24 v6, 272, v6
v_lshrrev_b32 v7, 5, v1
v_lshl_add_u32 v6, v7, 4, v6
v_add_u32 v6, s43, v6
s_mov_b32 m0, s43
v_mov_b32 v192, 0
v_mov_b32 v193, 0
v_mov_b32 v194, 0
v_mov_b32 v195, 0
v_mov_b32 v196, 0
v_mov_b32 v197, 0
v_mov_b32 v198, 0
v_mov_b32 v199, 0
v_mov_b32 v200, 0
v_mov_b32 v201, 0
v_mov_b32 v202, 0
v_mov_b32 v203, 0
v_mov_b32 v204, 0
v_mov_b32 v205, 0
v_mov_b32 v206, 0
v_mov_b32 v207, 0
s_add_u32 s47, s43, 21232
v_and_b32 v126, 31, v1
v_lshrrev_b32 v127, 5, v1
v_cmp_eq_u32 s[48:49], 1, v127
v_cmp_eq_u32 s[50:51], 0, v126
v_cmp_eq_u32 s[52:53], 32, v1
v_lshlrev_b32 v96, 5, v126
v_lshl_add_u32 v96, v127, 4, v96
v_add_u32 v96, s47, v96
v_lshlrev_b32 v60, 4, v126
v_add_u32 v60, 1024, v60
v_lshlrev_b32 v61, 3, v126
v_add_u32 v97, 1536, v61
v_add_u32 v98, 1792, v61
v_add_u32 v62, 8, v60
v_cndmask_b32 v97, v60, v97, s[48:49]
v_cndmask_b32 v98, v62, v98, s[48:49]
v_add_u32 v97, s47, v97
v_add_u32 v98, s47, v98
v_lshlrev_b32 v99, 2, v126
v_lshl_add_u32 v99, v127, 9, v99
v_add_u32 v99, 2048, v99
v_add_u32 v99, s47, v99
v_mov_b32 v100, s47
v_add_u32 v100, -16, v100
v_lshlrev_b32 v242, 4, v1
v_add_u32 v101, s43, v242
v_lshrrev_b32 v60, 1, v1
v_mul_u32_u24 v60, 4160, v60
v_and_b32 v61, 1, v1
v_lshl_add_u32 v60, v61, 4, v60
v_add_u32 v102, s43, v60
v_lshlrev_b32 v63, 2, v127
v_mul_u32_u24 v60, 4160, v127
v_lshl_add_u32 v103, v126, 4, v60
v_add_u32 v103, s43, v103
v_add_u32 v103, 32, v103
v_lshlrev_b32 v104, 5, v126
v_add_u32 v104, s47, v104
v_sub_u32 v104, v104, v63
v_add_u32 v104, -8, v104
v_lshlrev_b32 v105, 4, v126
v_add_u32 v105, s47, v105
v_add_u32 v105, 1024, v105
v_sub_u32 v106, v105, v63
v_add_u32 v60, -4, v105
v_cndmask_b32 v107, v105, v60, s[52:53]
v_add_u32 v60, -4, v106
v_add_u32 v61, -8, v106
v_cndmask_b32 v108, v60, v61, s[50:51]
v_lshlrev_b32 v109, 3, v126
v_add_u32 v109, s47, v109
v_add_u32 v109, 1536, v109
v_sub_u32 v110, v109, v63
v_add_u32 v60, -4, v110
v_cndmask_b32 v111, v110, v60, s[50:51]
v_add_u32 v60, -4, v109
v_cndmask_b32 v112, v109, v60, s[52:53]
v_lshlrev_b32 v113, 2, v126
v_add_u32 v113, s47, v113
v_add_u32 v113, 2048, v113
v_add_u32 v60, -4, v113
v_cndmask_b32 v114, v113, v60, s[52:53]
v_and_b32 v61, 1, v1
v_xor_b32 v60, 1, v127
v_and_b32 v60, v60, v61
v_cmp_eq_u32 s[54:55], 1, v60
v_xor_b32 v60, 1, v61
v_and_b32 v60, v60, v127
v_cmp_eq_u32 s[56:57], 1, v60
v_bfe_u32 v60, v1, 2, 2
v_mul_u32_u24 v60, 4160, v60
v_lshrrev_b32 v61, 4, v1
v_lshlrev_b32 v62, 4, v61
v_sub_u32 v60, v60, v62
v_and_b32 v62, 3, v1
v_lshl_add_u32 v60, v62, 3, v60
v_add_u32 v60, 56, v60
v_add_u32 v240, s43, v60
v_and_b32 v60, 15, v1
v_lshlrev_b32 v244, 4, v60
v_lshl_add_u32 v244, v61, 2, v244
v_lshlrev_b32 v60, 5, v60
v_lshl_add_u32 v60, v61, 4, v60
v_add_u32 v60, 16640, v60
v_add_u32 v241, s43, v60
v_lshlrev_b32 v245, 1, v244
v_add_u32 v246, 17120, v245
v_add_u32 v246, s43, v246
v_mov_b32 v120, 0
v_mov_b32 v121, 0
v_mov_b32 v122, 0
v_mov_b32 v123, 0
s_mov_b64 exec, 0x3fffffff
ds_write_b128 v101, v[120:123] offset:16640
s_mov_b64 exec, -1
s_add_u32 s12, s32, 0x7e0000
s_addc_u32 s13, s33, 0
s_mov_b32 s14, 0x280000
s_mov_b32 s15, 0x20000
s_add_u32 s8, s32, 0x1220000
s_addc_u32 s9, s33, 0
s_mov_b32 s10, 0x2000
s_mov_b32 s11, 0x20000
s_add_u32 s36, s32, 0xf90000
s_addc_u32 s37, s33, 0
s_mov_b32 s38, 0x280000
s_mov_b32 s39, 0x20000
s_lshl_b32 s46, s40, 12
s_lshr_b32 s45, s40, 6
s_lshl_b32 s45, s45, 7
s_add_u32 s45, s45, 0
s_mov_b32 s44, 0x3fb8aa3b
s_mov_b32 s34, 0x32a57060
s_mov_b32 s35, 0x3f317218
s_waitcnt vmcnt(20)
v_lshlrev_b32 v3, 16, v3
v_mul_f32 v26, s44, v3
v_fma_f32 v27, v3, s44, -v26
v_fma_f32 v27, v3, s34, v27
v_exp_f32 v26, v26
v_mul_f32 v27, s35, v27
v_fma_f32 v26, v26, v27, v26
v_cvt_pk_bf16_f32 v3, v26, v26
v_lshlrev_b32 v3, 16, v3
s_waitcnt vmcnt(14)
v_lshlrev_b32 v8, 16, v8
v_lshlrev_b32 v9, 16, v9
v_lshlrev_b32 v10, 16, v10
v_lshlrev_b32 v11, 16, v11
v_lshlrev_b32 v12, 16, v12
v_lshlrev_b32 v13, 16, v13
v_mul_f32 v70, v3, v8
v_mul_f32 v71, v3, v9
v_mul_f32 v10, v3, v10
v_mul_f32 v11, v3, v11
v_mul_f32 v70, s44, v70
v_mul_f32 v71, 0.15915494, v71
v_mul_f32 v28, v12, v10
v_mul_f32 v29, v12, v11
v_exp_f32 v72, v70
v_rndne_f32 v74, v71
v_mul_f32 v77, 0x41000000, v70
v_mul_f32 v78, 0x41000000, v71
v_mul_f32 v82, 0x43800000, v70
v_mul_f32 v83, 0x43800000, v71
v_fma_f32 v28, -v13, v11, v28
v_fma_f32 v29, v13, v10, v29
v_sub_f32 v73, v71, v74
v_exp_f32 v77, v77
v_rndne_f32 v79, v78
v_exp_f32 v82, v82
v_rndne_f32 v84, v83
v_sub_f32 v78, v78, v79
v_sub_f32 v83, v83, v84
v_cos_f32 v75, v73
v_sin_f32 v76, v73
v_cos_f32 v80, v78
v_sin_f32 v81, v78
v_cos_f32 v85, v83
v_sin_f32 v86, v83
v_mul_f32 v30, v72, v75
v_mul_f32 v31, v72, v76
v_mul_f32 v36, v77, v80
v_mul_f32 v37, v77, v81
v_mul_f32 v38, v82, v85
v_mul_f32 v39, v82, v86
v_mul_f32 v72, v30, v30
v_mul_f32 v73, v30, v31
v_mul_f32 v74, v36, v36
v_mul_f32 v75, v36, v37
v_fma_f32 v32, -v31, v31, v72
v_add_f32 v33, v73, v73
v_fma_f32 v40, -v37, v37, v74
v_add_f32 v41, v75, v75
v_mul_f32 v72, v32, v32
v_mul_f32 v73, v32, v33
v_mul_f32 v74, v40, v40
v_mul_f32 v75, v40, v41
v_fma_f32 v34, -v33, v33, v72
v_add_f32 v35, v73, v73
v_fma_f32 v40, -v41, v41, v74
v_add_f32 v41, v75, v75
v_mul_f32 v74, v40, v40
v_mul_f32 v75, v40, v41
v_fma_f32 v40, -v41, v41, v74
v_add_f32 v41, v75, v75
v_mul_f32 v74, v40, v40
v_mul_f32 v75, v40, v41
v_fma_f32 v40, -v41, v41, v74
v_add_f32 v41, v75, v75
v_cvt_pk_bf16_f32 v88, v28, -v29
ds_write_addtid_b32 v88 offset:0
v_mov_b32 v94, 0x3f80
ds_write_addtid_b32 v94 offset:5712
v_cvt_pk_bf16_f32 v89, v40, v41
ds_write_addtid_b32 v89 offset:10064
v_mul_f32 v64, v28, v30
v_mul_f32 v65, v28, v31
v_mul_f32 v68, v40, v36
v_mul_f32 v69, v40, v37
v_fma_f32 v56, -v29, v31, v64
v_fma_f32 v57, v29, v30, v65
v_fma_f32 v62, -v41, v37, v68
v_fma_f32 v63, v41, v36, v69
v_cvt_pk_bf16_f32 v90, v56, -v57
ds_write_addtid_b32 v90 offset:272
v_cvt_pk_bf16_f32 v91, v36, v37
ds_write_addtid_b32 v91 offset:5984
v_cvt_pk_bf16_f32 v92, v62, v63
ds_write_addtid_b32 v92 offset:10336
v_mul_f32 v64, v56, v30
v_mul_f32 v65, v56, v31
v_mul_f32 v66, v36, v36
v_mul_f32 v67, v36, v37
v_mul_f32 v68, v62, v36
v_mul_f32 v69, v62, v37
v_fma_f32 v56, -v57, v31, v64
v_fma_f32 v57, v57, v30, v65
v_fma_f32 v60, -v37, v37, v66
v_add_f32 v61, v67, v67
v_fma_f32 v62, -v63, v37, v68
v_fma_f32 v63, v63, v36, v69
v_cvt_pk_bf16_f32 v93, v56, -v57
ds_write_addtid_b32 v93 offset:544
v_cvt_pk_bf16_f32 v88, v60, v61
ds_write_addtid_b32 v88 offset:6256
v_cvt_pk_bf16_f32 v89, v62, v63
ds_write_addtid_b32 v89 offset:10608
v_mul_f32 v64, v56, v30
v_mul_f32 v65, v56, v31
v_mul_f32 v66, v60, v36
v_mul_f32 v67, v60, v37
v_mul_f32 v68, v62, v36
v_mul_f32 v69, v62, v37
v_fma_f32 v56, -v57, v31, v64
v_fma_f32 v57, v57, v30, v65
v_fma_f32 v60, -v61, v37, v66
v_fma_f32 v61, v61, v36, v67
v_fma_f32 v62, -v63, v37, v68
v_fma_f32 v63, v63, v36, v69
v_cvt_pk_bf16_f32 v90, v56, -v57
ds_write_addtid_b32 v90 offset:816
v_cvt_pk_bf16_f32 v91, v60, v61
ds_write_addtid_b32 v91 offset:6528
v_cvt_pk_bf16_f32 v92, v62, v63
ds_write_addtid_b32 v92 offset:10880
v_mul_f32 v64, v56, v30
v_mul_f32 v65, v56, v31
v_mul_f32 v66, v60, v36
v_mul_f32 v67, v60, v37
v_mul_f32 v68, v62, v36
v_mul_f32 v69, v62, v37
v_fma_f32 v56, -v57, v31, v64
v_fma_f32 v57, v57, v30, v65
v_fma_f32 v60, -v61, v37, v66
v_fma_f32 v61, v61, v36, v67
v_fma_f32 v62, -v63, v37, v68
v_fma_f32 v63, v63, v36, v69
v_cvt_pk_bf16_f32 v93, v56, -v57
ds_write_addtid_b32 v93 offset:1088
v_cvt_pk_bf16_f32 v88, v60, v61
ds_write_addtid_b32 v88 offset:6800
v_cvt_pk_bf16_f32 v89, v62, v63
ds_write_addtid_b32 v89 offset:11152
v_mul_f32 v64, v56, v30
v_mul_f32 v65, v56, v31
v_mul_f32 v66, v60, v36
v_mul_f32 v67, v60, v37
v_mul_f32 v68, v62, v36
v_mul_f32 v69, v62, v37
v_fma_f32 v56, -v57, v31, v64
v_fma_f32 v57, v57, v30, v65
v_fma_f32 v60, -v61, v37, v66
v_fma_f32 v61, v61, v36, v67
v_fma_f32 v62, -v63, v37, v68
v_fma_f32 v63, v63, v36, v69
v_cvt_pk_bf16_f32 v90, v56, -v57
ds_write_addtid_b32 v90 offset:1360
v_cvt_pk_bf16_f32 v91, v60, v61
ds_write_addtid_b32 v91 offset:7072
v_cvt_pk_bf16_f32 v92, v62, v63
ds_write_addtid_b32 v92 offset:11424
v_mul_f32 v64, v56, v30
v_mul_f32 v65, v56, v31
v_mul_f32 v66, v60, v36
v_mul_f32 v67, v60, v37
v_mul_f32 v68, v62, v36
v_mul_f32 v69, v62, v37
v_fma_f32 v56, -v57, v31, v64
v_fma_f32 v57, v57, v30, v65
v_fma_f32 v60, -v61, v37, v66
v_fma_f32 v61, v61, v36, v67
v_fma_f32 v62, -v63, v37, v68
v_fma_f32 v63, v63, v36, v69
v_cvt_pk_bf16_f32 v93, v56, -v57
ds_write_addtid_b32 v93 offset:1632
v_cvt_pk_bf16_f32 v88, v60, v61
ds_write_addtid_b32 v88 offset:7344
v_cvt_pk_bf16_f32 v89, v62, v63
ds_write_addtid_b32 v89 offset:11696
v_mul_f32 v64, v56, v30
v_mul_f32 v65, v56, v31
v_mul_f32 v66, v60, v36
v_mul_f32 v67, v60, v37
v_mul_f32 v68, v62, v36
v_mul_f32 v69, v62, v37
v_fma_f32 v56, -v57, v31, v64
v_fma_f32 v57, v57, v30, v65
v_fma_f32 v60, -v61, v37, v66
v_fma_f32 v61, v61, v36, v67
v_fma_f32 v62, -v63, v37, v68
v_fma_f32 v63, v63, v36, v69
v_cvt_pk_bf16_f32 v90, v56, -v57
ds_write_addtid_b32 v90 offset:1904
v_cvt_pk_bf16_f32 v91, v60, v61
ds_write_addtid_b32 v91 offset:7616
v_cvt_pk_bf16_f32 v92, v62, v63
ds_write_addtid_b32 v92 offset:11968
v_mul_f32 v64, v28, v38
v_mul_f32 v65, v28, v39
v_mul_f32 v66, v60, v36
v_mul_f32 v67, v60, v37
v_mul_f32 v68, v62, v36
v_mul_f32 v69, v62, v37
v_fma_f32 v58, -v29, v39, v64
v_fma_f32 v59, v29, v38, v65
v_fma_f32 v60, -v61, v37, v66
v_fma_f32 v61, v61, v36, v67
v_fma_f32 v62, -v63, v37, v68
v_fma_f32 v63, v63, v36, v69
v_cvt_pk_bf16_f32 v93, v58, -v59
ds_write_addtid_b32 v93 offset:2176
v_cvt_pk_bf16_f32 v88, v60, v61
ds_write_addtid_b32 v88 offset:7888
v_cvt_pk_bf16_f32 v89, v62, v63
ds_write_addtid_b32 v89 offset:12240
v_mul_f32 v64, v58, v32
v_mul_f32 v65, v58, v33
v_mul_f32 v66, v60, v36
v_mul_f32 v67, v60, v37
v_mul_f32 v68, v62, v36
v_mul_f32 v69, v62, v37
v_fma_f32 v56, -v59, v33, v64
v_fma_f32 v57, v59, v32, v65
v_fma_f32 v60, -v61, v37, v66
v_fma_f32 v61, v61, v36, v67
v_fma_f32 v62, -v63, v37, v68
v_fma_f32 v63, v63, v36, v69
v_cvt_pk_bf16_f32 v90, v56, -v57
ds_write_addtid_b32 v90 offset:2448
v_cvt_pk_bf16_f32 v91, v60, v61
ds_write_addtid_b32 v91 offset:8160
v_cvt_pk_bf16_f32 v92, v62, v63
ds_write_addtid_b32 v92 offset:12512
v_mul_f32 v64, v56, v32
v_mul_f32 v65, v56, v33
v_mul_f32 v66, v60, v36
v_mul_f32 v67, v60, v37
v_mul_f32 v68, v62, v36
v_mul_f32 v69, v62, v37
v_fma_f32 v56, -v57, v33, v64
v_fma_f32 v57, v57, v32, v65
v_fma_f32 v60, -v61, v37, v66
v_fma_f32 v61, v61, v36, v67
v_fma_f32 v62, -v63, v37, v68
v_fma_f32 v63, v63, v36, v69
v_cvt_pk_bf16_f32 v93, v56, -v57
ds_write_addtid_b32 v93 offset:2720
v_cvt_pk_bf16_f32 v88, v60, v61
ds_write_addtid_b32 v88 offset:8432
v_cvt_pk_bf16_f32 v89, v62, v63
ds_write_addtid_b32 v89 offset:12784
v_mul_f32 v64, v56, v32
v_mul_f32 v65, v56, v33
v_mul_f32 v66, v60, v36
v_mul_f32 v67, v60, v37
v_mul_f32 v68, v62, v36
v_mul_f32 v69, v62, v37
s_waitcnt vmcnt(8)
v_fma_f32 v56, -v57, v33, v64
v_fma_f32 v57, v57, v32, v65
v_fma_f32 v60, -v61, v37, v66
v_fma_f32 v61, v61, v36, v67
v_fma_f32 v62, -v63, v37, v68
v_fma_f32 v63, v63, v36, v69
v_lshlrev_b32 v14, 16, v14
v_cvt_pk_bf16_f32 v90, v56, -v57
ds_write_addtid_b32 v90 offset:2992
v_cvt_pk_bf16_f32 v91, v60, v61
ds_write_addtid_b32 v91 offset:8704
v_cvt_pk_bf16_f32 v92, v62, v63
ds_write_addtid_b32 v92 offset:13056
v_mul_f32 v64, v58, v38
v_mul_f32 v65, v58, v39
v_mul_f32 v66, v60, v36
v_mul_f32 v67, v60, v37
v_mul_f32 v68, v62, v36
v_mul_f32 v69, v62, v37
v_lshlrev_b32 v15, 16, v15
v_fma_f32 v58, -v59, v39, v64
v_fma_f32 v59, v59, v38, v65
v_fma_f32 v60, -v61, v37, v66
v_fma_f32 v61, v61, v36, v67
v_fma_f32 v62, -v63, v37, v68
v_fma_f32 v63, v63, v36, v69
v_lshlrev_b32 v16, 16, v16
v_cvt_pk_bf16_f32 v93, v58, -v59
ds_write_addtid_b32 v93 offset:3264
v_cvt_pk_bf16_f32 v88, v60, v61
ds_write_addtid_b32 v88 offset:8976
v_cvt_pk_bf16_f32 v89, v62, v63
ds_write_addtid_b32 v89 offset:13328
v_lshlrev_b32 v17, 16, v17
v_mul_f32 v64, v58, v34
v_mul_f32 v65, v58, v35
v_mul_f32 v66, v60, v36
v_mul_f32 v67, v60, v37
v_mul_f32 v68, v62, v36
v_mul_f32 v69, v62, v37
v_lshlrev_b32 v18, 16, v18
v_fma_f32 v56, -v59, v35, v64
v_fma_f32 v57, v59, v34, v65
v_fma_f32 v60, -v61, v37, v66
v_fma_f32 v61, v61, v36, v67
v_fma_f32 v62, -v63, v37, v68
v_fma_f32 v63, v63, v36, v69
v_lshlrev_b32 v19, 16, v19
v_cvt_pk_bf16_f32 v90, v56, -v57
ds_write_addtid_b32 v90 offset:3536
v_cvt_pk_bf16_f32 v91, v60, v61
ds_write_addtid_b32 v91 offset:9248
v_cvt_pk_bf16_f32 v92, v62, v63
ds_write_addtid_b32 v92 offset:13600
v_mul_f32 v70, v3, v14
v_mul_f32 v64, v58, v38
v_mul_f32 v65, v58, v39
v_mul_f32 v66, v60, v36
v_mul_f32 v67, v60, v37
v_mul_f32 v68, v62, v36
v_mul_f32 v69, v62, v37
v_mul_f32 v71, v3, v15
v_fma_f32 v58, -v59, v39, v64
v_fma_f32 v59, v59, v38, v65
v_fma_f32 v60, -v61, v37, v66
v_fma_f32 v61, v61, v36, v67
v_fma_f32 v62, -v63, v37, v68
v_fma_f32 v63, v63, v36, v69
v_mul_f32 v16, v3, v16
v_cvt_pk_bf16_f32 v93, v58, -v59
ds_write_addtid_b32 v93 offset:3808
v_cvt_pk_bf16_f32 v88, v60, v61
ds_write_addtid_b32 v88 offset:9520
v_cvt_pk_bf16_f32 v89, v62, v63
ds_write_addtid_b32 v89 offset:13872
v_mul_f32 v64, v58, v34
v_mul_f32 v65, v58, v35
v_mul_f32 v66, v60, v36
v_mul_f32 v67, v60, v37
v_mul_f32 v68, v62, v36
v_mul_f32 v69, v62, v37
v_mul_f32 v17, v3, v17
v_fma_f32 v56, -v59, v35, v64
v_fma_f32 v57, v59, v34, v65
v_fma_f32 v60, -v61, v37, v66
v_fma_f32 v61, v61, v36, v67
v_fma_f32 v62, -v63, v37, v68
v_fma_f32 v63, v63, v36, v69
v_mul_f32 v70, s44, v70
v_cvt_pk_bf16_f32 v90, v56, -v57
ds_write_addtid_b32 v90 offset:4080
v_cvt_pk_bf16_f32 v91, v60, v61
ds_write_addtid_b32 v91 offset:9792
v_cvt_pk_bf16_f32 v92, v62, v63
ds_write_addtid_b32 v92 offset:14144
v_mul_f32 v71, 0.15915494, v71
v_mul_f32 v64, v58, v38
v_mul_f32 v65, v58, v39
v_mul_f32 v42, v18, v16
v_mul_f32 v43, v18, v17
v_exp_f32 v72, v70
v_fma_f32 v58, -v59, v39, v64
v_fma_f32 v59, v59, v38, v65
v_rndne_f32 v74, v71
v_mul_f32 v77, 0x41000000, v70
v_mul_f32 v78, 0x41000000, v71
v_cvt_pk_bf16_f32 v93, v58, -v59
ds_write_addtid_b32 v93 offset:4352
v_mul_f32 v82, 0x43800000, v70
v_mul_f32 v83, 0x43800000, v71
v_mul_f32 v64, v58, v38
v_mul_f32 v65, v58, v39
v_fma_f32 v42, -v19, v17, v42
v_fma_f32 v43, v19, v16, v43
v_sub_f32 v73, v71, v74
v_fma_f32 v58, -v59, v39, v64
v_fma_f32 v59, v59, v38, v65
v_exp_f32 v77, v77
v_rndne_f32 v79, v78
v_exp_f32 v82, v82
v_cvt_pk_bf16_f32 v88, v58, -v59
ds_write_addtid_b32 v88 offset:4624
v_rndne_f32 v84, v83
v_sub_f32 v78, v78, v79
v_mul_f32 v64, v58, v38
v_mul_f32 v65, v58, v39
v_sub_f32 v83, v83, v84
v_cos_f32 v75, v73
v_sin_f32 v76, v73
v_fma_f32 v58, -v59, v39, v64
v_fma_f32 v59, v59, v38, v65
v_cos_f32 v80, v78
v_sin_f32 v81, v78
v_cos_f32 v85, v83
v_cvt_pk_bf16_f32 v89, v58, -v59
ds_write_addtid_b32 v89 offset:4896
v_sin_f32 v86, v83
v_mul_f32 v44, v72, v75
v_mul_f32 v64, v58, v38
v_mul_f32 v65, v58, v39
v_mul_f32 v45, v72, v76
v_mul_f32 v50, v77, v80
v_mul_f32 v51, v77, v81
v_fma_f32 v58, -v59, v39, v64
v_fma_f32 v59, v59, v38, v65
v_mul_f32 v52, v82, v85
v_mul_f32 v53, v82, v86
v_mul_f32 v72, v44, v44
v_mul_f32 v73, v44, v45
v_cvt_pk_bf16_f32 v90, v58, -v59
ds_write_addtid_b32 v90 offset:5168
v_mul_f32 v74, v50, v50
v_mul_f32 v75, v50, v51
v_fma_f32 v46, -v45, v45, v72
v_add_f32 v47, v73, v73
v_mul_f32 v64, v58, v38
v_mul_f32 v65, v58, v39
v_fma_f32 v54, -v51, v51, v74
v_add_f32 v55, v75, v75
v_mul_f32 v72, v46, v46
v_mul_f32 v73, v46, v47
v_mul_f32 v74, v54, v54
v_mul_f32 v75, v54, v55
v_fma_f32 v58, -v59, v39, v64
v_fma_f32 v59, v59, v38, v65
v_fma_f32 v48, -v47, v47, v72
v_add_f32 v49, v73, v73
v_fma_f32 v54, -v55, v55, v74
v_add_f32 v55, v75, v75
v_mul_f32 v74, v54, v54
v_mul_f32 v75, v54, v55
v_cvt_pk_bf16_f32 v91, v58, -v59
ds_write_addtid_b32 v91 offset:5440
v_fma_f32 v54, -v55, v55, v74
v_add_f32 v55, v75, v75
v_mul_f32 v74, v54, v54
v_mul_f32 v75, v54, v55
v_fma_f32 v54, -v55, v55, v74
v_add_f32 v55, v75, v75
ds_read_b128 v[128:131], v6 offset:0
ds_read_b128 v[132:135], v6 offset:5712
ds_read_b128 v[136:139], v6 offset:32
ds_read_b128 v[140:143], v6 offset:5744
ds_read_b128 v[144:147], v6 offset:64
ds_read_b128 v[148:151], v6 offset:5776
ds_read_b128 v[152:155], v6 offset:96
ds_read_b128 v[156:159], v6 offset:5808
ds_read_b128 v[160:163], v6 offset:128
ds_read_b128 v[164:167], v6 offset:5840
ds_read_b128 v[168:171], v6 offset:160
ds_read_b128 v[172:175], v6 offset:5872
ds_read_b128 v[176:179], v6 offset:192
ds_read_b128 v[180:183], v6 offset:5904
ds_read_b128 v[184:187], v6 offset:224
ds_read_b128 v[188:191], v6 offset:5936
v_cvt_pk_bf16_f32 v92, v42, -v43
ds_write_addtid_b32 v92 offset:0
v_cvt_pk_bf16_f32 v93, v54, v55
ds_write_addtid_b32 v93 offset:10064
v_mul_f32 v64, v42, v44
v_mul_f32 v65, v42, v45
v_mul_f32 v68, v54, v50
v_mul_f32 v69, v54, v51
v_fma_f32 v56, -v43, v45, v64
v_fma_f32 v57, v43, v44, v65
v_fma_f32 v62, -v55, v51, v68
v_fma_f32 v63, v55, v50, v69
s_waitcnt lgkmcnt(15)
v_mfma_f32_32x32x16_bf16 v[192:207], v[128:131], v[132:135], v[192:207]
v_cvt_pk_bf16_f32 v88, v56, -v57
ds_write_addtid_b32 v88 offset:272
v_cvt_pk_bf16_f32 v89, v50, v51
ds_write_addtid_b32 v89 offset:5984
v_cvt_pk_bf16_f32 v90, v62, v63
ds_write_addtid_b32 v90 offset:10336
v_mul_f32 v64, v56, v44
v_mul_f32 v65, v56, v45
v_mul_f32 v66, v50, v50
v_mul_f32 v67, v50, v51
v_mul_f32 v68, v62, v50
v_mul_f32 v69, v62, v51
v_fma_f32 v56, -v57, v45, v64
v_fma_f32 v57, v57, v44, v65
v_fma_f32 v60, -v51, v51, v66
v_add_f32 v61, v67, v67
v_fma_f32 v62, -v63, v51, v68
v_fma_f32 v63, v63, v50, v69
s_waitcnt lgkmcnt(15)
v_mfma_f32_32x32x16_bf16 v[192:207], v[136:139], v[140:143], v[192:207]
v_cvt_pk_bf16_f32 v91, v56, -v57
ds_write_addtid_b32 v91 offset:544
v_cvt_pk_bf16_f32 v92, v60, v61
ds_write_addtid_b32 v92 offset:6256
v_cvt_pk_bf16_f32 v93, v62, v63
ds_write_addtid_b32 v93 offset:10608
v_mul_f32 v64, v56, v44
v_mul_f32 v65, v56, v45
v_mul_f32 v66, v60, v50
v_mul_f32 v67, v60, v51
v_mul_f32 v68, v62, v50
v_mul_f32 v69, v62, v51
v_fma_f32 v56, -v57, v45, v64
v_fma_f32 v57, v57, v44, v65
v_fma_f32 v60, -v61, v51, v66
v_fma_f32 v61, v61, v50, v67
v_fma_f32 v62, -v63, v51, v68
v_fma_f32 v63, v63, v50, v69
v_mfma_f32_32x32x16_bf16 v[192:207], v[144:147], v[148:151], v[192:207]
v_cvt_pk_bf16_f32 v88, v56, -v57
ds_write_addtid_b32 v88 offset:816
v_cvt_pk_bf16_f32 v89, v60, v61
ds_write_addtid_b32 v89 offset:6528
v_cvt_pk_bf16_f32 v90, v62, v63
ds_write_addtid_b32 v90 offset:10880
v_mul_f32 v64, v56, v44
v_mul_f32 v65, v56, v45
v_mul_f32 v66, v60, v50
v_mul_f32 v67, v60, v51
v_mul_f32 v68, v62, v50
v_mul_f32 v69, v62, v51
v_fma_f32 v56, -v57, v45, v64
v_fma_f32 v57, v57, v44, v65
v_fma_f32 v60, -v61, v51, v66
v_fma_f32 v61, v61, v50, v67
v_fma_f32 v62, -v63, v51, v68
v_fma_f32 v63, v63, v50, v69
s_waitcnt lgkmcnt(15)
v_mfma_f32_32x32x16_bf16 v[192:207], v[152:155], v[156:159], v[192:207]
v_cvt_pk_bf16_f32 v91, v56, -v57
ds_write_addtid_b32 v91 offset:1088
v_cvt_pk_bf16_f32 v92, v60, v61
ds_write_addtid_b32 v92 offset:6800
v_cvt_pk_bf16_f32 v93, v62, v63
ds_write_addtid_b32 v93 offset:11152
v_mul_f32 v64, v56, v44
v_mul_f32 v65, v56, v45
v_mul_f32 v66, v60, v50
v_mul_f32 v67, v60, v51
v_mul_f32 v68, v62, v50
v_mul_f32 v69, v62, v51
v_fma_f32 v56, -v57, v45, v64
v_fma_f32 v57, v57, v44, v65
v_fma_f32 v60, -v61, v51, v66
v_fma_f32 v61, v61, v50, v67
v_fma_f32 v62, -v63, v51, v68
v_fma_f32 v63, v63, v50, v69
v_mfma_f32_32x32x16_bf16 v[192:207], v[160:163], v[164:167], v[192:207]
v_cvt_pk_bf16_f32 v88, v56, -v57
ds_write_addtid_b32 v88 offset:1360
v_cvt_pk_bf16_f32 v89, v60, v61
ds_write_addtid_b32 v89 offset:7072
v_cvt_pk_bf16_f32 v90, v62, v63
ds_write_addtid_b32 v90 offset:11424
v_mul_f32 v64, v56, v44
v_mul_f32 v65, v56, v45
v_mul_f32 v66, v60, v50
v_mul_f32 v67, v60, v51
v_mul_f32 v68, v62, v50
v_mul_f32 v69, v62, v51
v_fma_f32 v56, -v57, v45, v64
v_fma_f32 v57, v57, v44, v65
v_fma_f32 v60, -v61, v51, v66
v_fma_f32 v61, v61, v50, v67
v_fma_f32 v62, -v63, v51, v68
v_fma_f32 v63, v63, v50, v69
v_mfma_f32_32x32x16_bf16 v[192:207], v[168:171], v[172:175], v[192:207]
v_cvt_pk_bf16_f32 v91, v56, -v57
ds_write_addtid_b32 v91 offset:1632
v_cvt_pk_bf16_f32 v92, v60, v61
ds_write_addtid_b32 v92 offset:7344
v_cvt_pk_bf16_f32 v93, v62, v63
ds_write_addtid_b32 v93 offset:11696
v_mul_f32 v64, v56, v44
v_mul_f32 v65, v56, v45
v_mul_f32 v66, v60, v50
v_mul_f32 v67, v60, v51
v_mul_f32 v68, v62, v50
v_mul_f32 v69, v62, v51
v_fma_f32 v56, -v57, v45, v64
v_fma_f32 v57, v57, v44, v65
v_fma_f32 v60, -v61, v51, v66
v_fma_f32 v61, v61, v50, v67
v_fma_f32 v62, -v63, v51, v68
v_fma_f32 v63, v63, v50, v69
s_waitcnt lgkmcnt(15)
v_mfma_f32_32x32x16_bf16 v[192:207], v[176:179], v[180:183], v[192:207]
v_cvt_pk_bf16_f32 v88, v56, -v57
ds_write_addtid_b32 v88 offset:1904
v_cvt_pk_bf16_f32 v89, v60, v61
ds_write_addtid_b32 v89 offset:7616
v_cvt_pk_bf16_f32 v90, v62, v63
ds_write_addtid_b32 v90 offset:11968
v_mul_f32 v64, v42, v52
v_mul_f32 v65, v42, v53
v_mul_f32 v66, v60, v50
v_mul_f32 v67, v60, v51
v_mul_f32 v68, v62, v50
v_mul_f32 v69, v62, v51
v_fma_f32 v58, -v43, v53, v64
v_fma_f32 v59, v43, v52, v65
v_fma_f32 v60, -v61, v51, v66
v_fma_f32 v61, v61, v50, v67
v_fma_f32 v62, -v63, v51, v68
v_fma_f32 v63, v63, v50, v69
v_mfma_f32_32x32x16_bf16 v[192:207], v[184:187], v[188:191], v[192:207]
v_cvt_pk_bf16_f32 v91, v58, -v59
ds_write_addtid_b32 v91 offset:2176
v_cvt_pk_bf16_f32 v92, v60, v61
ds_write_addtid_b32 v92 offset:7888
v_cvt_pk_bf16_f32 v93, v62, v63
ds_write_addtid_b32 v93 offset:12240
v_mul_f32 v64, v58, v46
v_mul_f32 v65, v58, v47
v_mul_f32 v66, v60, v50
v_mul_f32 v67, v60, v51
v_mul_f32 v68, v62, v50
v_mul_f32 v69, v62, v51
v_fma_f32 v56, -v59, v47, v64
v_fma_f32 v57, v59, v46, v65
v_fma_f32 v60, -v61, v51, v66
v_fma_f32 v61, v61, v50, v67
v_fma_f32 v62, -v63, v51, v68
v_fma_f32 v63, v63, v50, v69
v_cvt_pk_bf16_f32 v88, v56, -v57
ds_write_addtid_b32 v88 offset:2448
v_cvt_pk_bf16_f32 v89, v60, v61
ds_write_addtid_b32 v89 offset:8160
v_cvt_pk_bf16_f32 v90, v62, v63
ds_write_addtid_b32 v90 offset:12512
v_mul_f32 v64, v56, v46
v_mul_f32 v65, v56, v47
v_mul_f32 v66, v60, v50
v_mul_f32 v67, v60, v51
v_mul_f32 v68, v62, v50
v_mul_f32 v69, v62, v51
v_fma_f32 v56, -v57, v47, v64
v_fma_f32 v57, v57, v46, v65
v_fma_f32 v60, -v61, v51, v66
v_fma_f32 v61, v61, v50, v67
v_fma_f32 v62, -v63, v51, v68
v_fma_f32 v63, v63, v50, v69
v_cvt_pk_bf16_f32 v91, v56, -v57
ds_write_addtid_b32 v91 offset:2720
v_cvt_pk_bf16_f32 v92, v60, v61
ds_write_addtid_b32 v92 offset:8432
v_cvt_pk_bf16_f32 v93, v62, v63
ds_write_addtid_b32 v93 offset:12784
v_mul_f32 v64, v56, v46
v_mul_f32 v65, v56, v47
v_mul_f32 v66, v60, v50
v_mul_f32 v67, v60, v51
v_mul_f32 v68, v62, v50
v_mul_f32 v69, v62, v51
s_waitcnt vmcnt(2)
v_fma_f32 v56, -v57, v47, v64
v_fma_f32 v57, v57, v46, v65
v_fma_f32 v60, -v61, v51, v66
v_fma_f32 v61, v61, v50, v67
v_fma_f32 v62, -v63, v51, v68
v_fma_f32 v63, v63, v50, v69
v_lshlrev_b32 v20, 16, v20
v_cvt_pk_bf16_f32 v88, v56, -v57
ds_write_addtid_b32 v88 offset:2992
v_cvt_pk_bf16_f32 v89, v60, v61
ds_write_addtid_b32 v89 offset:8704
v_cvt_pk_bf16_f32 v90, v62, v63
ds_write_addtid_b32 v90 offset:13056
v_mul_f32 v64, v58, v52
v_mul_f32 v65, v58, v53
v_mul_f32 v66, v60, v50
v_mul_f32 v67, v60, v51
v_mul_f32 v68, v62, v50
v_mul_f32 v69, v62, v51
v_lshlrev_b32 v21, 16, v21
v_fma_f32 v58, -v59, v53, v64
v_fma_f32 v59, v59, v52, v65
v_fma_f32 v60, -v61, v51, v66
v_fma_f32 v61, v61, v50, v67
v_fma_f32 v62, -v63, v51, v68
v_fma_f32 v63, v63, v50, v69
v_lshlrev_b32 v22, 16, v22
v_cvt_pk_bf16_f32 v91, v58, -v59
ds_write_addtid_b32 v91 offset:3264
v_cvt_pk_bf16_f32 v92, v60, v61
ds_write_addtid_b32 v92 offset:8976
v_cvt_pk_bf16_f32 v93, v62, v63
ds_write_addtid_b32 v93 offset:13328
v_lshlrev_b32 v23, 16, v23
v_mul_f32 v64, v58, v48
v_mul_f32 v65, v58, v49
v_mul_f32 v66, v60, v50
v_mul_f32 v67, v60, v51
v_mul_f32 v68, v62, v50
v_mul_f32 v69, v62, v51
v_lshlrev_b32 v24, 16, v24
v_fma_f32 v56, -v59, v49, v64
v_fma_f32 v57, v59, v48, v65
v_fma_f32 v60, -v61, v51, v66
v_fma_f32 v61, v61, v50, v67
v_fma_f32 v62, -v63, v51, v68
v_fma_f32 v63, v63, v50, v69
v_lshlrev_b32 v25, 16, v25
v_cvt_pk_bf16_f32 v88, v56, -v57
ds_write_addtid_b32 v88 offset:3536
v_cvt_pk_bf16_f32 v89, v60, v61
ds_write_addtid_b32 v89 offset:9248
v_cvt_pk_bf16_f32 v90, v62, v63
ds_write_addtid_b32 v90 offset:13600
v_mul_f32 v70, v3, v20
v_mul_f32 v64, v58, v52
v_mul_f32 v65, v58, v53
v_mul_f32 v66, v60, v50
v_mul_f32 v67, v60, v51
v_mul_f32 v68, v62, v50
v_mul_f32 v69, v62, v51
v_mul_f32 v71, v3, v21
v_fma_f32 v58, -v59, v53, v64
v_fma_f32 v59, v59, v52, v65
v_fma_f32 v60, -v61, v51, v66
v_fma_f32 v61, v61, v50, v67
v_fma_f32 v62, -v63, v51, v68
v_fma_f32 v63, v63, v50, v69
v_mul_f32 v22, v3, v22
v_cvt_pk_bf16_f32 v91, v58, -v59
ds_write_addtid_b32 v91 offset:3808
v_cvt_pk_bf16_f32 v92, v60, v61
ds_write_addtid_b32 v92 offset:9520
v_cvt_pk_bf16_f32 v93, v62, v63
ds_write_addtid_b32 v93 offset:13872
v_mul_f32 v64, v58, v48
v_mul_f32 v65, v58, v49
v_mul_f32 v66, v60, v50
v_mul_f32 v67, v60, v51
v_mul_f32 v68, v62, v50
v_mul_f32 v69, v62, v51
v_mul_f32 v23, v3, v23
v_fma_f32 v56, -v59, v49, v64
v_fma_f32 v57, v59, v48, v65
v_fma_f32 v60, -v61, v51, v66
v_fma_f32 v61, v61, v50, v67
v_fma_f32 v62, -v63, v51, v68
v_fma_f32 v63, v63, v50, v69
v_mul_f32 v70, s44, v70
v_cvt_pk_bf16_f32 v88, v56, -v57
ds_write_addtid_b32 v88 offset:4080
v_cvt_pk_bf16_f32 v89, v60, v61
ds_write_addtid_b32 v89 offset:9792
v_cvt_pk_bf16_f32 v90, v62, v63
ds_write_addtid_b32 v90 offset:14144
v_mul_f32 v71, 0.15915494, v71
v_mul_f32 v64, v58, v52
v_mul_f32 v65, v58, v53
v_mul_f32 v28, v24, v22
v_mul_f32 v29, v24, v23
v_exp_f32 v72, v70
v_fma_f32 v58, -v59, v53, v64
v_fma_f32 v59, v59, v52, v65
v_rndne_f32 v74, v71
v_mul_f32 v77, 0x41000000, v70
v_mul_f32 v78, 0x41000000, v71
v_cvt_pk_bf16_f32 v91, v58, -v59
ds_write_addtid_b32 v91 offset:4352
v_mul_f32 v82, 0x43800000, v70
v_mul_f32 v83, 0x43800000, v71
v_mul_f32 v64, v58, v52
v_mul_f32 v65, v58, v53
v_fma_f32 v28, -v25, v23, v28
v_fma_f32 v29, v25, v22, v29
v_sub_f32 v73, v71, v74
v_fma_f32 v58, -v59, v53, v64
v_fma_f32 v59, v59, v52, v65
v_exp_f32 v77, v77
v_rndne_f32 v79, v78
v_exp_f32 v82, v82
v_cvt_pk_bf16_f32 v92, v58, -v59
ds_write_addtid_b32 v92 offset:4624
v_rndne_f32 v84, v83
v_sub_f32 v78, v78, v79
v_mul_f32 v64, v58, v52
v_mul_f32 v65, v58, v53
v_sub_f32 v83, v83, v84
v_cos_f32 v75, v73
v_sin_f32 v76, v73
v_fma_f32 v58, -v59, v53, v64
v_fma_f32 v59, v59, v52, v65
v_cos_f32 v80, v78
v_sin_f32 v81, v78
v_cos_f32 v85, v83
v_cvt_pk_bf16_f32 v93, v58, -v59
ds_write_addtid_b32 v93 offset:4896
v_sin_f32 v86, v83
v_mul_f32 v30, v72, v75
v_mul_f32 v64, v58, v52
v_mul_f32 v65, v58, v53
v_mul_f32 v31, v72, v76
v_mul_f32 v36, v77, v80
v_mul_f32 v37, v77, v81
v_fma_f32 v58, -v59, v53, v64
v_fma_f32 v59, v59, v52, v65
v_mul_f32 v38, v82, v85
v_mul_f32 v39, v82, v86
v_mul_f32 v72, v30, v30
v_mul_f32 v73, v30, v31
v_cvt_pk_bf16_f32 v88, v58, -v59
ds_write_addtid_b32 v88 offset:5168
v_mul_f32 v74, v36, v36
v_mul_f32 v75, v36, v37
v_fma_f32 v32, -v31, v31, v72
v_add_f32 v33, v73, v73
v_mul_f32 v64, v58, v52
v_mul_f32 v65, v58, v53
v_fma_f32 v40, -v37, v37, v74
v_add_f32 v41, v75, v75
v_mul_f32 v72, v32, v32
v_mul_f32 v73, v32, v33
v_mul_f32 v74, v40, v40
v_mul_f32 v75, v40, v41
v_fma_f32 v58, -v59, v53, v64
v_fma_f32 v59, v59, v52, v65
v_fma_f32 v34, -v33, v33, v72
v_add_f32 v35, v73, v73
v_fma_f32 v40, -v41, v41, v74
v_add_f32 v41, v75, v75
v_mul_f32 v74, v40, v40
v_mul_f32 v75, v40, v41
v_cvt_pk_bf16_f32 v89, v58, -v59
ds_write_addtid_b32 v89 offset:5440
v_fma_f32 v40, -v41, v41, v74
v_add_f32 v41, v75, v75
v_mul_f32 v74, v40, v40
v_mul_f32 v75, v40, v41
v_fma_f32 v40, -v41, v41, v74
v_add_f32 v41, v75, v75
ds_read_b128 v[128:131], v6 offset:0
ds_read_b128 v[132:135], v6 offset:5712
ds_read_b128 v[136:139], v6 offset:32
ds_read_b128 v[140:143], v6 offset:5744
ds_read_b128 v[144:147], v6 offset:64
ds_read_b128 v[148:151], v6 offset:5776
ds_read_b128 v[152:155], v6 offset:96
ds_read_b128 v[156:159], v6 offset:5808
ds_read_b128 v[160:163], v6 offset:128
ds_read_b128 v[164:167], v6 offset:5840
ds_read_b128 v[168:171], v6 offset:160
ds_read_b128 v[172:175], v6 offset:5872
ds_read_b128 v[176:179], v6 offset:192
ds_read_b128 v[180:183], v6 offset:5904
ds_read_b128 v[184:187], v6 offset:224
ds_read_b128 v[188:191], v6 offset:5936
s_waitcnt vmcnt(0)
v_readfirstlane_b32 s58, v251
s_nop 0
s_cmp_lg_u32 s58, 0
s_cbranch_scc1 L_have_nonce_29
s_load_dwordx2 s[60:61], s[0:1], 120
v_mov_b32 v250, 0
s_mov_b32 s59, 0
s_waitcnt lgkmcnt(0)
L_nonce_30:
global_load_dword v251, v250, s[60:61] sc1
s_waitcnt vmcnt(0)
v_readfirstlane_b32 s58, v251
s_add_u32 s59, s59, 1
s_cmp_lg_u32 s58, 0
s_cbranch_scc1 L_nonced_31
s_cmp_lt_u32 s59, 16384
s_cbranch_scc0 L_to_32
s_sleep 2
s_branch L_nonce_30
L_to_32:
L_nonced_31:
L_have_nonce_29:
v_cvt_pk_bf16_f32 v90, v28, -v29
ds_write_addtid_b32 v90 offset:0
v_cvt_pk_bf16_f32 v91, v40, v41
ds_write_addtid_b32 v91 offset:10064
v_mul_f32 v64, v28, v30
v_mul_f32 v65, v28, v31
v_mul_f32 v68, v40, v36
v_mul_f32 v69, v40, v37
v_fma_f32 v56, -v29, v31, v64
v_fma_f32 v57, v29, v30, v65
v_fma_f32 v62, -v41, v37, v68
v_fma_f32 v63, v41, v36, v69
s_waitcnt lgkmcnt(15)
v_mfma_f32_32x32x16_bf16 v[192:207], v[128:131], v[132:135], v[192:207]
v_cvt_pk_bf16_f32 v92, v56, -v57
ds_write_addtid_b32 v92 offset:272
v_cvt_pk_bf16_f32 v93, v36, v37
ds_write_addtid_b32 v93 offset:5984
v_cvt_pk_bf16_f32 v88, v62, v63
ds_write_addtid_b32 v88 offset:10336
v_mul_f32 v64, v56, v30
v_mul_f32 v65, v56, v31
v_mul_f32 v66, v36, v36
v_mul_f32 v67, v36, v37
v_mul_f32 v68, v62, v36
v_mul_f32 v69, v62, v37
v_fma_f32 v56, -v57, v31, v64
v_fma_f32 v57, v57, v30, v65
v_fma_f32 v60, -v37, v37, v66
v_add_f32 v61, v67, v67
v_fma_f32 v62, -v63, v37, v68
v_fma_f32 v63, v63, v36, v69
s_waitcnt lgkmcnt(15)
v_mfma_f32_32x32x16_bf16 v[192:207], v[136:139], v[140:143], v[192:207]
v_cvt_pk_bf16_f32 v89, v56, -v57
ds_write_addtid_b32 v89 offset:544
v_cvt_pk_bf16_f32 v90, v60, v61
ds_write_addtid_b32 v90 offset:6256
v_cvt_pk_bf16_f32 v91, v62, v63
ds_write_addtid_b32 v91 offset:10608
v_mul_f32 v64, v56, v30
v_mul_f32 v65, v56, v31
v_mul_f32 v66, v60, v36
v_mul_f32 v67, v60, v37
v_mul_f32 v68, v62, v36
v_mul_f32 v69, v62, v37
v_fma_f32 v56, -v57, v31, v64
v_fma_f32 v57, v57, v30, v65
v_fma_f32 v60, -v61, v37, v66
v_fma_f32 v61, v61, v36, v67
v_fma_f32 v62, -v63, v37, v68
v_fma_f32 v63, v63, v36, v69
v_mfma_f32_32x32x16_bf16 v[192:207], v[144:147], v[148:151], v[192:207]
v_cvt_pk_bf16_f32 v92, v56, -v57
ds_write_addtid_b32 v92 offset:816
v_cvt_pk_bf16_f32 v93, v60, v61
ds_write_addtid_b32 v93 offset:6528
v_cvt_pk_bf16_f32 v88, v62, v63
ds_write_addtid_b32 v88 offset:10880
v_mul_f32 v64, v56, v30
v_mul_f32 v65, v56, v31
v_mul_f32 v66, v60, v36
v_mul_f32 v67, v60, v37
v_mul_f32 v68, v62, v36
v_mul_f32 v69, v62, v37
v_fma_f32 v56, -v57, v31, v64
v_fma_f32 v57, v57, v30, v65
v_fma_f32 v60, -v61, v37, v66
v_fma_f32 v61, v61, v36, v67
v_fma_f32 v62, -v63, v37, v68
v_fma_f32 v63, v63, v36, v69
s_waitcnt lgkmcnt(15)
v_mfma_f32_32x32x16_bf16 v[192:207], v[152:155], v[156:159], v[192:207]
v_cvt_pk_bf16_f32 v89, v56, -v57
ds_write_addtid_b32 v89 offset:1088
v_cvt_pk_bf16_f32 v90, v60, v61
ds_write_addtid_b32 v90 offset:6800
v_cvt_pk_bf16_f32 v91, v62, v63
ds_write_addtid_b32 v91 offset:11152
v_mul_f32 v64, v56, v30
v_mul_f32 v65, v56, v31
v_mul_f32 v66, v60, v36
v_mul_f32 v67, v60, v37
v_mul_f32 v68, v62, v36
v_mul_f32 v69, v62, v37
v_fma_f32 v56, -v57, v31, v64
v_fma_f32 v57, v57, v30, v65
v_fma_f32 v60, -v61, v37, v66
v_fma_f32 v61, v61, v36, v67
v_fma_f32 v62, -v63, v37, v68
v_fma_f32 v63, v63, v36, v69
v_mfma_f32_32x32x16_bf16 v[192:207], v[160:163], v[164:167], v[192:207]
v_cvt_pk_bf16_f32 v92, v56, -v57
ds_write_addtid_b32 v92 offset:1360
v_cvt_pk_bf16_f32 v93, v60, v61
ds_write_addtid_b32 v93 offset:7072
v_cvt_pk_bf16_f32 v88, v62, v63
ds_write_addtid_b32 v88 offset:11424
v_mul_f32 v64, v56, v30
v_mul_f32 v65, v56, v31
v_mul_f32 v66, v60, v36
v_mul_f32 v67, v60, v37
v_mul_f32 v68, v62, v36
v_mul_f32 v69, v62, v37
v_fma_f32 v56, -v57, v31, v64
v_fma_f32 v57, v57, v30, v65
v_fma_f32 v60, -v61, v37, v66
v_fma_f32 v61, v61, v36, v67
v_fma_f32 v62, -v63, v37, v68
v_fma_f32 v63, v63, v36, v69
v_mfma_f32_32x32x16_bf16 v[192:207], v[168:171], v[172:175], v[192:207]
v_cvt_pk_bf16_f32 v89, v56, -v57
ds_write_addtid_b32 v89 offset:1632
v_cvt_pk_bf16_f32 v90, v60, v61
ds_write_addtid_b32 v90 offset:7344
v_cvt_pk_bf16_f32 v91, v62, v63
ds_write_addtid_b32 v91 offset:11696
v_mul_f32 v64, v56, v30
v_mul_f32 v65, v56, v31
v_mul_f32 v66, v60, v36
v_mul_f32 v67, v60, v37
v_mul_f32 v68, v62, v36
v_mul_f32 v69, v62, v37
v_fma_f32 v56, -v57, v31, v64
v_fma_f32 v57, v57, v30, v65
v_fma_f32 v60, -v61, v37, v66
v_fma_f32 v61, v61, v36, v67
v_fma_f32 v62, -v63, v37, v68
v_fma_f32 v63, v63, v36, v69
s_waitcnt lgkmcnt(15)
v_mfma_f32_32x32x16_bf16 v[192:207], v[176:179], v[180:183], v[192:207]
v_cvt_pk_bf16_f32 v92, v56, -v57
ds_write_addtid_b32 v92 offset:1904
v_cvt_pk_bf16_f32 v93, v60, v61
ds_write_addtid_b32 v93 offset:7616
v_cvt_pk_bf16_f32 v88, v62, v63
ds_write_addtid_b32 v88 offset:11968
v_mul_f32 v64, v28, v38
v_mul_f32 v65, v28, v39
v_mul_f32 v66, v60, v36
v_mul_f32 v67, v60, v37
v_mul_f32 v68, v62, v36
v_mul_f32 v69, v62, v37
v_fma_f32 v58, -v29, v39, v64
v_fma_f32 v59, v29, v38, v65
v_fma_f32 v60, -v61, v37, v66
v_fma_f32 v61, v61, v36, v67
v_fma_f32 v62, -v63, v37, v68
v_fma_f32 v63, v63, v36, v69
v_mfma_f32_32x32x16_bf16 v[192:207], v[184:187], v[188:191], v[192:207]
v_cvt_pk_bf16_f32 v89, v58, -v59
ds_write_addtid_b32 v89 offset:2176
v_cvt_pk_bf16_f32 v90, v60, v61
ds_write_addtid_b32 v90 offset:7888
v_cvt_pk_bf16_f32 v91, v62, v63
ds_write_addtid_b32 v91 offset:12240
v_mul_f32 v64, v58, v32
v_mul_f32 v65, v58, v33
v_mul_f32 v66, v60, v36
v_mul_f32 v67, v60, v37
v_mul_f32 v68, v62, v36
v_mul_f32 v69, v62, v37
v_fma_f32 v56, -v59, v33, v64
v_fma_f32 v57, v59, v32, v65
v_fma_f32 v60, -v61, v37, v66
v_fma_f32 v61, v61, v36, v67
v_fma_f32 v62, -v63, v37, v68
v_fma_f32 v63, v63, v36, v69
v_cvt_pk_bf16_f32 v92, v56, -v57
ds_write_addtid_b32 v92 offset:2448
v_cvt_pk_bf16_f32 v93, v60, v61
ds_write_addtid_b32 v93 offset:8160
v_cvt_pk_bf16_f32 v88, v62, v63
ds_write_addtid_b32 v88 offset:12512
v_mul_f32 v64, v56, v32
v_mul_f32 v65, v56, v33
v_mul_f32 v66, v60, v36
v_mul_f32 v67, v60, v37
v_mul_f32 v68, v62, v36
v_mul_f32 v69, v62, v37
v_fma_f32 v56, -v57, v33, v64
v_fma_f32 v57, v57, v32, v65
v_fma_f32 v60, -v61, v37, v66
v_fma_f32 v61, v61, v36, v67
v_fma_f32 v62, -v63, v37, v68
v_fma_f32 v63, v63, v36, v69
v_cvt_pk_bf16_f32 v89, v56, -v57
ds_write_addtid_b32 v89 offset:2720
v_cvt_pk_bf16_f32 v90, v60, v61
ds_write_addtid_b32 v90 offset:8432
v_cvt_pk_bf16_f32 v91, v62, v63
ds_write_addtid_b32 v91 offset:12784
v_mul_f32 v64, v56, v32
v_mul_f32 v65, v56, v33
v_mul_f32 v66, v60, v36
v_mul_f32 v67, v60, v37
v_mul_f32 v68, v62, v36
v_mul_f32 v69, v62, v37
v_fma_f32 v56, -v57, v33, v64
v_fma_f32 v57, v57, v32, v65
v_fma_f32 v60, -v61, v37, v66
v_fma_f32 v61, v61, v36, v67
v_fma_f32 v62, -v63, v37, v68
v_fma_f32 v63, v63, v36, v69
v_cvt_pk_bf16_f32 v92, v56, -v57
ds_write_addtid_b32 v92 offset:2992
v_cvt_pk_bf16_f32 v93, v60, v61
ds_write_addtid_b32 v93 offset:8704
v_cvt_pk_bf16_f32 v88, v62, v63
ds_write_addtid_b32 v88 offset:13056
v_mul_f32 v64, v58, v38
v_mul_f32 v65, v58, v39
v_mul_f32 v66, v60, v36
v_mul_f32 v67, v60, v37
v_mul_f32 v68, v62, v36
v_mul_f32 v69, v62, v37
v_fma_f32 v58, -v59, v39, v64
v_fma_f32 v59, v59, v38, v65
v_fma_f32 v60, -v61, v37, v66
v_fma_f32 v61, v61, v36, v67
v_fma_f32 v62, -v63, v37, v68
v_fma_f32 v63, v63, v36, v69
v_cvt_pk_bf16_f32 v89, v58, -v59
ds_write_addtid_b32 v89 offset:3264
v_cvt_pk_bf16_f32 v90, v60, v61
ds_write_addtid_b32 v90 offset:8976
v_cvt_pk_bf16_f32 v91, v62, v63
ds_write_addtid_b32 v91 offset:13328
v_mul_f32 v64, v58, v34
v_mul_f32 v65, v58, v35
v_mul_f32 v66, v60, v36
v_mul_f32 v67, v60, v37
v_mul_f32 v68, v62, v36
v_mul_f32 v69, v62, v37
v_fma_f32 v56, -v59, v35, v64
v_fma_f32 v57, v59, v34, v65
v_fma_f32 v60, -v61, v37, v66
v_fma_f32 v61, v61, v36, v67
v_fma_f32 v62, -v63, v37, v68
v_fma_f32 v63, v63, v36, v69
v_cvt_pk_bf16_f32 v92, v56, -v57
ds_write_addtid_b32 v92 offset:3536
v_cvt_pk_bf16_f32 v93, v60, v61
ds_write_addtid_b32 v93 offset:9248
v_cvt_pk_bf16_f32 v88, v62, v63
ds_write_addtid_b32 v88 offset:13600
v_mul_f32 v64, v58, v38
v_mul_f32 v65, v58, v39
v_mul_f32 v66, v60, v36
v_mul_f32 v67, v60, v37
v_mul_f32 v68, v62, v36
v_mul_f32 v69, v62, v37
v_fma_f32 v58, -v59, v39, v64
v_fma_f32 v59, v59, v38, v65
v_fma_f32 v60, -v61, v37, v66
v_fma_f32 v61, v61, v36, v67
v_fma_f32 v62, -v63, v37, v68
v_fma_f32 v63, v63, v36, v69
v_cvt_pk_bf16_f32 v89, v58, -v59
ds_write_addtid_b32 v89 offset:3808
v_cvt_pk_bf16_f32 v90, v60, v61
ds_write_addtid_b32 v90 offset:9520
v_cvt_pk_bf16_f32 v91, v62, v63
ds_write_addtid_b32 v91 offset:13872
v_mul_f32 v64, v58, v34
v_mul_f32 v65, v58, v35
v_mul_f32 v66, v60, v36
v_mul_f32 v67, v60, v37
v_mul_f32 v68, v62, v36
v_mul_f32 v69, v62, v37
v_fma_f32 v56, -v59, v35, v64
v_fma_f32 v57, v59, v34, v65
v_fma_f32 v60, -v61, v37, v66
v_fma_f32 v61, v61, v36, v67
v_fma_f32 v62, -v63, v37, v68
v_fma_f32 v63, v63, v36, v69
v_cvt_pk_bf16_f32 v92, v56, -v57
ds_write_addtid_b32 v92 offset:4080
v_cvt_pk_bf16_f32 v93, v60, v61
ds_write_addtid_b32 v93 offset:9792
v_cvt_pk_bf16_f32 v88, v62, v63
ds_write_addtid_b32 v88 offset:14144
v_mul_f32 v64, v58, v38
v_mul_f32 v65, v58, v39
v_fma_f32 v58, -v59, v39, v64
v_fma_f32 v59, v59, v38, v65
v_cvt_pk_bf16_f32 v89, v58, -v59
ds_write_addtid_b32 v89 offset:4352
v_mul_f32 v64, v58, v38
v_mul_f32 v65, v58, v39
v_fma_f32 v58, -v59, v39, v64
v_fma_f32 v59, v59, v38, v65
v_cvt_pk_bf16_f32 v90, v58, -v59
ds_write_addtid_b32 v90 offset:4624
v_mul_f32 v64, v58, v38
v_mul_f32 v65, v58, v39
v_fma_f32 v58, -v59, v39, v64
v_fma_f32 v59, v59, v38, v65
v_cvt_pk_bf16_f32 v91, v58, -v59
ds_write_addtid_b32 v91 offset:4896
v_mul_f32 v64, v58, v38
v_mul_f32 v65, v58, v39
v_fma_f32 v58, -v59, v39, v64
v_fma_f32 v59, v59, v38, v65
v_cvt_pk_bf16_f32 v92, v58, -v59
ds_write_addtid_b32 v92 offset:5168
v_mul_f32 v64, v58, v38
v_mul_f32 v65, v58, v39
v_fma_f32 v58, -v59, v39, v64
v_fma_f32 v59, v59, v38, v65
v_cvt_pk_bf16_f32 v93, v58, -v59
ds_write_addtid_b32 v93 offset:5440
v_lshlrev_b32 v248, 2, v1
s_mov_b32 exec_hi, 0
buffer_load_dword v250, v248, s[8:11], s45 offen sc1
s_mov_b64 exec, -1
ds_read_b128 v[128:131], v6 offset:0
ds_read_b128 v[132:135], v6 offset:5712
ds_read_b128 v[136:139], v6 offset:32
ds_read_b128 v[140:143], v6 offset:5744
ds_read_b128 v[144:147], v6 offset:64
ds_read_b128 v[148:151], v6 offset:5776
ds_read_b128 v[152:155], v6 offset:96
ds_read_b128 v[156:159], v6 offset:5808
ds_read_b128 v[160:163], v6 offset:128
ds_read_b128 v[164:167], v6 offset:5840
ds_read_b128 v[168:171], v6 offset:160
ds_read_b128 v[172:175], v6 offset:5872
ds_read_b128 v[176:179], v6 offset:192
ds_read_b128 v[180:183], v6 offset:5904
ds_read_b128 v[184:187], v6 offset:224
ds_read_b128 v[188:191], v6 offset:5936
s_waitcnt lgkmcnt(14)
v_mfma_f32_32x32x16_bf16 v[192:207], v[128:131], v[132:135], v[192:207]
s_waitcnt lgkmcnt(12)
v_mfma_f32_32x32x16_bf16 v[192:207], v[136:139], v[140:143], v[192:207]
s_waitcnt lgkmcnt(10)
v_mfma_f32_32x32x16_bf16 v[192:207], v[144:147], v[148:151], v[192:207]
s_waitcnt lgkmcnt(8)
v_mfma_f32_32x32x16_bf16 v[192:207], v[152:155], v[156:159], v[192:207]
s_waitcnt lgkmcnt(6)
v_mfma_f32_32x32x16_bf16 v[192:207], v[160:163], v[164:167], v[192:207]
s_waitcnt lgkmcnt(4)
v_mfma_f32_32x32x16_bf16 v[192:207], v[168:171], v[172:175], v[192:207]
s_waitcnt lgkmcnt(2)
v_mfma_f32_32x32x16_bf16 v[192:207], v[176:179], v[180:183], v[192:207]
s_waitcnt lgkmcnt(0)
v_mfma_f32_32x32x16_bf16 v[192:207], v[184:187], v[188:191], v[192:207]
v_mov_b32 v120, 0
v_mov_b32 v121, 0
v_mov_b32 v122, 0
v_mov_b32 v123, 0
s_nop 7
ds_write_b128 v96, v[192:195]
ds_write_b64 v97, v[196:197]
ds_write_b64 v98, v[198:199]
s_mov_b32 exec_hi, 1
ds_write_b32 v99, v200
s_mov_b32 exec_hi, 0
ds_write_b32 v99, v201 offset:128
ds_write_b32 v99, v202 offset:256
ds_write_b32 v99, v203 offset:384
s_mov_b64 exec, 1
ds_write_b128 v100, v[120:123]
s_mov_b64 exec, 0xff
ds_write_b128 v102, v[120:123]
s_mov_b64 exec, -1
s_waitcnt vmcnt(0)
s_mov_b32 exec_hi, 0
v_cmp_ne_u32 vcc, s58, v250
s_mov_b64 exec, -1
s_nop 0
s_cmp_eq_u64 vcc, 0
s_cbranch_scc1 L_ut_ready_33
v_lshlrev_b32 v248, 2, v1
s_mov_b32 s59, 0
s_mov_b32 exec_lo, 0xffffffff
s_mov_b32 exec_hi, 0x0
L_poll_34:
buffer_load_dword v250, v248, s[8:11], s45 offen sc1
s_waitcnt vmcnt(0)
v_cmp_ne_u32 vcc, s58, v250
s_nop 1
s_cmp_eq_u64 vcc, 0
s_cbranch_scc1 L_polled_35
s_add_u32 s59, s59, 1
s_cmp_lt_u32 s59, 16384
s_cbranch_scc0 L_to_36
s_sleep 8
s_branch L_poll_34
L_to_36:
L_polled_35:
s_mov_b64 exec, -1
L_ut_ready_33:
s_add_u32 m0, s43, 17120
s_add_u32 s45, s46, 0
buffer_load_dwordx4 v242, s[12:15], s45 offen sc1 lds
s_add_u32 m0, s43, 18144
s_add_u32 s45, s46, 1024
buffer_load_dwordx4 v242, s[12:15], s45 offen sc1 lds
s_add_u32 m0, s43, 19168
s_add_u32 s45, s46, 2048
buffer_load_dwordx4 v242, s[12:15], s45 offen sc1 lds
s_add_u32 m0, s43, 20192
s_add_u32 s45, s46, 3072
buffer_load_dwordx4 v242, s[12:15], s45 offen sc1 lds
ds_read2_b32 v[8:9], v104 offset0:0 offset1:1
ds_read2_b32 v[10:11], v104 offset0:2 offset1:3
ds_read2_b32 v[12:13], v104 offset0:4 offset1:5
ds_read2_b32 v[14:15], v104 offset0:6 offset1:7
ds_read2_b32 v[16:17], v104 offset0:8 offset1:9
ds_read2_b32 v[18:19], v106 offset0:1 offset1:2
ds_read2_b32 v[20:21], v106 offset0:3 offset1:4
ds_read2_b32 v[22:23], v105 offset0:0 offset1:2
ds_read_b32 v24, v107
ds_read2_b32 v[26:27], v108 offset0:0 offset1:1
ds_read2_b32 v[28:29], v109 offset0:0 offset1:1
ds_read_b32 v30, v109 offset:8
ds_read2_b32 v[32:33], v110 offset0:1 offset1:2
ds_read_b32 v34, v111
ds_read_b32 v35, v112
ds_read2_b32 v[36:37], v109 offset0:64 offset1:65
ds_read_b32 v38, v109 offset:264
ds_read2_b32 v[40:41], v110 offset0:65 offset1:66
ds_read_b32 v42, v110 offset:256
ds_read2_b32 v[44:45], v113 offset0:0 offset1:1
ds_read_b32 v46, v114
ds_read2_b32 v[48:49], v113 offset0:32 offset1:33
ds_read2_b32 v[52:53], v113 offset0:64 offset1:65
ds_read2_b32 v[56:57], v113 offset0:96 offset1:97
v_mov_b32 v192, 0
v_mov_b32 v193, 0
v_mov_b32 v194, 0
v_mov_b32 v195, 0
v_mov_b32 v196, 0
v_mov_b32 v197, 0
v_mov_b32 v198, 0
v_mov_b32 v199, 0
v_mov_b32 v200, 0
v_mov_b32 v201, 0
v_mov_b32 v202, 0
v_mov_b32 v203, 0
v_mov_b32 v204, 0
v_mov_b32 v205, 0
v_mov_b32 v206, 0
v_mov_b32 v207, 0
v_mov_b32 v208, 0
v_mov_b32 v209, 0
v_mov_b32 v210, 0
v_mov_b32 v211, 0
v_mov_b32 v212, 0
v_mov_b32 v213, 0
v_mov_b32 v214, 0
v_mov_b32 v215, 0
v_mov_b32 v216, 0
v_mov_b32 v217, 0
v_mov_b32 v218, 0
v_mov_b32 v219, 0
v_mov_b32 v220, 0
v_mov_b32 v221, 0
v_mov_b32 v222, 0
v_mov_b32 v223, 0
s_waitcnt lgkmcnt(15)
v_cvt_pk_bf16_f32 v128, v10, v11
v_cvt_pk_bf16_f32 v129, v12, v13
v_cvt_pk_bf16_f32 v130, v14, v15
v_cvt_pk_bf16_f32 v131, v16, v17
ds_write_b128 v103, v[128:131] offset:0
v_cvt_pk_bf16_f32 v132, v8, v9
v_cvt_pk_bf16_f32 v133, v10, v11
v_cvt_pk_bf16_f32 v134, v12, v13
v_cvt_pk_bf16_f32 v135, v14, v15
ds_write_b128 v103, v[132:135] offset:8320
s_waitcnt lgkmcnt(15)
v_cvt_pk_bf16_f32 v136, v24, v22
v_cvt_pk_bf16_f32 v137, v18, v19
v_cvt_pk_bf16_f32 v138, v23, v23
v_cvt_pk_bf16_f32 v139, v20, v21
ds_write_b128 v103, v[136:139] offset:512
v_cvt_pk_bf16_f32 v140, v26, v27
v_cvt_pk_bf16_f32 v141, v24, v22
v_cvt_pk_bf16_f32 v142, v18, v19
v_cvt_pk_bf16_f32 v143, v23, v23
ds_write_b128 v103, v[140:143] offset:8832
s_waitcnt lgkmcnt(13)
v_cvt_pk_bf16_f32 v144, v28, v28
v_cvt_pk_bf16_f32 v145, v28, v32
v_cvt_pk_bf16_f32 v146, v29, v29
v_cvt_pk_bf16_f32 v147, v33, v30
ds_write_b128 v103, v[144:147] offset:1024
v_cvt_pk_bf16_f32 v148, v34, v35
v_cvt_pk_bf16_f32 v149, v28, v28
v_cvt_pk_bf16_f32 v150, v28, v32
v_cvt_pk_bf16_f32 v151, v29, v29
ds_write_b128 v103, v[148:151] offset:9344
s_waitcnt lgkmcnt(11)
v_cvt_pk_bf16_f32 v152, v36, v36
v_cvt_pk_bf16_f32 v153, v36, v40
v_cvt_pk_bf16_f32 v154, v37, v37
v_cvt_pk_bf16_f32 v155, v41, v38
ds_write_b128 v103, v[152:155] offset:1536
v_cvt_pk_bf16_f32 v156, v42, v36
v_cvt_pk_bf16_f32 v157, v36, v36
v_cvt_pk_bf16_f32 v158, v36, v40
v_cvt_pk_bf16_f32 v159, v37, v37
ds_write_b128 v103, v[156:159] offset:9856
s_waitcnt lgkmcnt(11)
v_cndmask_b32 v60, v44, v45, s[54:55]
v_cndmask_b32 v61, v45, v44, s[56:57]
v_cvt_pk_bf16_f32 v128, v44, v44
v_cvt_pk_bf16_f32 v129, v44, v44
v_cvt_pk_bf16_f32 v130, v60, v61
v_cvt_pk_bf16_f32 v131, v45, v45
ds_write_b128 v103, v[128:131] offset:2048
v_cvt_pk_bf16_f32 v132, v46, v44
v_cvt_pk_bf16_f32 v133, v44, v44
v_cvt_pk_bf16_f32 v134, v44, v44
v_cvt_pk_bf16_f32 v135, v60, v61
ds_write_b128 v103, v[132:135] offset:10368
s_waitcnt lgkmcnt(12)
v_cndmask_b32 v60, v48, v49, s[54:55]
v_cndmask_b32 v61, v49, v48, s[56:57]
v_cvt_pk_bf16_f32 v136, v48, v48
v_cvt_pk_bf16_f32 v137, v48, v48
v_cvt_pk_bf16_f32 v138, v60, v61
v_cvt_pk_bf16_f32 v139, v49, v49
ds_write_b128 v103, v[136:139] offset:2560
v_cvt_pk_bf16_f32 v140, v48, v48
v_cvt_pk_bf16_f32 v141, v48, v48
v_cvt_pk_bf16_f32 v142, v48, v48
v_cvt_pk_bf16_f32 v143, v60, v61
ds_write_b128 v103, v[140:143] offset:10880
s_waitcnt lgkmcnt(13)
v_cndmask_b32 v60, v52, v53, s[54:55]
v_cndmask_b32 v61, v53, v52, s[56:57]
v_cvt_pk_bf16_f32 v144, v52, v52
v_cvt_pk_bf16_f32 v145, v52, v52
v_cvt_pk_bf16_f32 v146, v60, v61
v_cvt_pk_bf16_f32 v147, v53, v53
ds_write_b128 v103, v[144:147] offset:3072
v_cvt_pk_bf16_f32 v148, v52, v52
v_cvt_pk_bf16_f32 v149, v52, v52
v_cvt_pk_bf16_f32 v150, v52, v52
v_cvt_pk_bf16_f32 v151, v60, v61
ds_write_b128 v103, v[148:151] offset:11392
s_waitcnt lgkmcnt(14)
v_cndmask_b32 v60, v56, v57, s[54:55]
v_cndmask_b32 v61, v57, v56, s[56:57]
v_cvt_pk_bf16_f32 v152, v56, v56
v_cvt_pk_bf16_f32 v153, v56, v56
v_cvt_pk_bf16_f32 v154, v60, v61
v_cvt_pk_bf16_f32 v155, v57, v57
ds_write_b128 v103, v[152:155] offset:3584
v_cvt_pk_bf16_f32 v156, v56, v56
v_cvt_pk_bf16_f32 v157, v56, v56
v_cvt_pk_bf16_f32 v158, v56, v56
v_cvt_pk_bf16_f32 v159, v60, v61
ds_write_b128 v103, v[156:159] offset:11904
s_setprio 2
ds_read_b64_tr_b16 v[92:93], v240 offset:456
ds_read_b64_tr_b16 v[94:95], v240 offset:448
ds_read_b64_tr_b16 v[124:125], v240 offset:968
ds_read_b64_tr_b16 v[126:127], v240 offset:960
ds_read_b64_tr_b16 v[156:157], v240 offset:1480
ds_read_b64_tr_b16 v[158:159], v240 offset:1472
ds_read_b64_tr_b16 v[188:189], v240 offset:1992
ds_read_b64_tr_b16 v[190:191], v240 offset:1984
ds_read_b64_tr_b16 v[88:89], v240 offset:392
ds_read_b64_tr_b16 v[90:91], v240 offset:384
ds_read_b64_tr_b16 v[120:121], v240 offset:904
ds_read_b64_tr_b16 v[122:123], v240 offset:896
ds_read_b64_tr_b16 v[152:153], v240 offset:1416
ds_read_b64_tr_b16 v[154:155], v240 offset:1408
ds_read_b64_tr_b16 v[184:185], v240 offset:1928
ds_read_b64_tr_b16 v[186:187], v240 offset:1920
s_waitcnt vmcnt(0)
ds_read_b128 v[224:227], v241 offset:0
ds_read_b128 v[228:231], v241 offset:64
ds_read_b128 v[232:235], v241 offset:128
ds_read_b128 v[236:239], v241 offset:192
ds_read_b64_tr_b16 v[84:85], v240 offset:328
ds_read_b64_tr_b16 v[86:87], v240 offset:320
ds_read_b64_tr_b16 v[116:117], v240 offset:840
ds_read_b64_tr_b16 v[118:119], v240 offset:832
ds_read_b64_tr_b16 v[148:149], v240 offset:1352
ds_read_b64_tr_b16 v[150:151], v240 offset:1344
ds_read_b64_tr_b16 v[180:181], v240 offset:1864
ds_read_b64_tr_b16 v[182:183], v240 offset:1856
s_waitcnt lgkmcnt(11)
v_mfma_f32_16x16x32_bf16 v[192:195], v[92:95], v[224:227], v[192:195]
v_mfma_f32_16x16x32_bf16 v[196:199], v[124:127], v[224:227], v[196:199]
v_mfma_f32_16x16x32_bf16 v[200:203], v[156:159], v[224:227], v[200:203]
v_mfma_f32_16x16x32_bf16 v[204:207], v[188:191], v[224:227], v[204:207]
ds_read_b128 v[224:227], v241 offset:256
ds_read_b64_tr_b16 v[80:81], v240 offset:264
ds_read_b64_tr_b16 v[82:83], v240 offset:256
ds_read_b64_tr_b16 v[112:113], v240 offset:776
ds_read_b64_tr_b16 v[114:115], v240 offset:768
ds_read_b64_tr_b16 v[144:145], v240 offset:1288
ds_read_b64_tr_b16 v[146:147], v240 offset:1280
ds_read_b64_tr_b16 v[176:177], v240 offset:1800
ds_read_b64_tr_b16 v[178:179], v240 offset:1792
s_waitcnt lgkmcnt(15)
v_mfma_f32_16x16x32_bf16 v[192:195], v[88:91], v[228:231], v[192:195]
v_mfma_f32_16x16x32_bf16 v[196:199], v[120:123], v[228:231], v[196:199]
v_mfma_f32_16x16x32_bf16 v[200:203], v[152:155], v[228:231], v[200:203]
v_mfma_f32_16x16x32_bf16 v[204:207], v[184:187], v[228:231], v[204:207]
ds_read_b128 v[228:231], v241 offset:320
ds_read_b64_tr_b16 v[76:77], v240 offset:200
ds_read_b64_tr_b16 v[78:79], v240 offset:192
ds_read_b64_tr_b16 v[108:109], v240 offset:712
ds_read_b64_tr_b16 v[110:111], v240 offset:704
ds_read_b64_tr_b16 v[140:141], v240 offset:1224
ds_read_b64_tr_b16 v[142:143], v240 offset:1216
ds_read_b64_tr_b16 v[172:173], v240 offset:1736
ds_read_b64_tr_b16 v[174:175], v240 offset:1728
v_mfma_f32_16x16x32_bf16 v[192:195], v[84:87], v[232:235], v[192:195]
s_waitcnt lgkmcnt(15)
v_mfma_f32_16x16x32_bf16 v[196:199], v[116:119], v[232:235], v[196:199]
v_mfma_f32_16x16x32_bf16 v[200:203], v[148:151], v[232:235], v[200:203]
v_mfma_f32_16x16x32_bf16 v[204:207], v[180:183], v[232:235], v[204:207]
ds_read_b128 v[232:235], v241 offset:384
ds_read_b64_tr_b16 v[72:73], v240 offset:136
ds_read_b64_tr_b16 v[74:75], v240 offset:128
ds_read_b64_tr_b16 v[104:105], v240 offset:648
ds_read_b64_tr_b16 v[106:107], v240 offset:640
ds_read_b64_tr_b16 v[136:137], v240 offset:1160
ds_read_b64_tr_b16 v[138:139], v240 offset:1152
ds_read_b64_tr_b16 v[168:169], v240 offset:1672
ds_read_b64_tr_b16 v[170:171], v240 offset:1664
v_mfma_f32_16x16x32_bf16 v[192:195], v[80:83], v[236:239], v[192:195]
s_waitcnt lgkmcnt(15)
v_mfma_f32_16x16x32_bf16 v[196:199], v[112:115], v[236:239], v[196:199]
v_mfma_f32_16x16x32_bf16 v[200:203], v[144:147], v[236:239], v[200:203]
v_mfma_f32_16x16x32_bf16 v[204:207], v[176:179], v[236:239], v[204:207]
ds_read_b128 v[236:239], v241 offset:448
ds_read_b64_tr_b16 v[68:69], v240 offset:72
ds_read_b64_tr_b16 v[70:71], v240 offset:64
ds_read_b64_tr_b16 v[100:101], v240 offset:584
ds_read_b64_tr_b16 v[102:103], v240 offset:576
ds_read_b64_tr_b16 v[132:133], v240 offset:1096
ds_read_b64_tr_b16 v[134:135], v240 offset:1088
ds_read_b64_tr_b16 v[164:165], v240 offset:1608
ds_read_b64_tr_b16 v[166:167], v240 offset:1600
v_mfma_f32_16x16x32_bf16 v[192:195], v[76:79], v[224:227], v[192:195]
s_waitcnt lgkmcnt(15)
v_mfma_f32_16x16x32_bf16 v[196:199], v[108:111], v[224:227], v[196:199]
v_mfma_f32_16x16x32_bf16 v[200:203], v[140:143], v[224:227], v[200:203]
v_mfma_f32_16x16x32_bf16 v[204:207], v[172:175], v[224:227], v[204:207]
ds_read_b128 v[224:227], v241 offset:512
ds_read_b64_tr_b16 v[64:65], v240 offset:8
ds_read_b64_tr_b16 v[66:67], v240 offset:0
ds_read_b64_tr_b16 v[96:97], v240 offset:520
ds_read_b64_tr_b16 v[98:99], v240 offset:512
ds_read_b64_tr_b16 v[128:129], v240 offset:1032
ds_read_b64_tr_b16 v[130:131], v240 offset:1024
ds_read_b64_tr_b16 v[160:161], v240 offset:1544
ds_read_b64_tr_b16 v[162:163], v240 offset:1536
v_mfma_f32_16x16x32_bf16 v[192:195], v[72:75], v[228:231], v[192:195]
s_waitcnt lgkmcnt(15)
v_mfma_f32_16x16x32_bf16 v[196:199], v[104:107], v[228:231], v[196:199]
v_mfma_f32_16x16x32_bf16 v[200:203], v[136:139], v[228:231], v[200:203]
v_mfma_f32_16x16x32_bf16 v[204:207], v[168:171], v[228:231], v[204:207]
ds_read_b128 v[228:231], v241 offset:576
v_mfma_f32_16x16x32_bf16 v[192:195], v[68:71], v[232:235], v[192:195]
s_waitcnt lgkmcnt(14)
v_mfma_f32_16x16x32_bf16 v[196:199], v[100:103], v[232:235], v[196:199]
s_waitcnt lgkmcnt(12)
v_mfma_f32_16x16x32_bf16 v[200:203], v[132:135], v[232:235], v[200:203]
s_waitcnt lgkmcnt(10)
v_mfma_f32_16x16x32_bf16 v[204:207], v[164:167], v[232:235], v[204:207]
ds_read_b128 v[232:235], v241 offset:640
s_waitcnt lgkmcnt(8)
v_mfma_f32_16x16x32_bf16 v[192:195], v[64:67], v[236:239], v[192:195]
s_waitcnt lgkmcnt(6)
v_mfma_f32_16x16x32_bf16 v[196:199], v[96:99], v[236:239], v[196:199]
s_waitcnt lgkmcnt(4)
v_mfma_f32_16x16x32_bf16 v[200:203], v[128:131], v[236:239], v[200:203]
s_waitcnt lgkmcnt(2)
v_mfma_f32_16x16x32_bf16 v[204:207], v[160:163], v[236:239], v[204:207]
ds_read_b128 v[236:239], v241 offset:704
v_mfma_f32_16x16x32_bf16 v[196:199], v[92:95], v[224:227], v[196:199]
v_mfma_f32_16x16x32_bf16 v[200:203], v[124:127], v[224:227], v[200:203]
v_mfma_f32_16x16x32_bf16 v[204:207], v[156:159], v[224:227], v[204:207]
v_mfma_f32_16x16x32_bf16 v[208:211], v[188:191], v[224:227], v[208:211]
ds_read_b128 v[224:227], v241 offset:768
s_waitcnt lgkmcnt(3)
v_mfma_f32_16x16x32_bf16 v[196:199], v[88:91], v[228:231], v[196:199]
v_mfma_f32_16x16x32_bf16 v[200:203], v[120:123], v[228:231], v[200:203]
v_mfma_f32_16x16x32_bf16 v[204:207], v[152:155], v[228:231], v[204:207]
v_mfma_f32_16x16x32_bf16 v[208:211], v[184:187], v[228:231], v[208:211]
ds_read_b128 v[228:231], v241 offset:832
s_waitcnt lgkmcnt(3)
v_mfma_f32_16x16x32_bf16 v[196:199], v[84:87], v[232:235], v[196:199]
v_mfma_f32_16x16x32_bf16 v[200:203], v[116:119], v[232:235], v[200:203]
v_mfma_f32_16x16x32_bf16 v[204:207], v[148:151], v[232:235], v[204:207]
v_mfma_f32_16x16x32_bf16 v[208:211], v[180:183], v[232:235], v[208:211]
ds_read_b128 v[232:235], v241 offset:896
s_waitcnt lgkmcnt(3)
v_mfma_f32_16x16x32_bf16 v[196:199], v[80:83], v[236:239], v[196:199]
v_mfma_f32_16x16x32_bf16 v[200:203], v[112:115], v[236:239], v[200:203]
v_mfma_f32_16x16x32_bf16 v[204:207], v[144:147], v[236:239], v[204:207]
v_mfma_f32_16x16x32_bf16 v[208:211], v[176:179], v[236:239], v[208:211]
ds_read_b128 v[236:239], v241 offset:960
s_waitcnt lgkmcnt(3)
v_mfma_f32_16x16x32_bf16 v[196:199], v[76:79], v[224:227], v[196:199]
v_mfma_f32_16x16x32_bf16 v[200:203], v[108:111], v[224:227], v[200:203]
v_mfma_f32_16x16x32_bf16 v[204:207], v[140:143], v[224:227], v[204:207]
v_mfma_f32_16x16x32_bf16 v[208:211], v[172:175], v[224:227], v[208:211]
ds_read_b128 v[224:227], v241 offset:1024
s_waitcnt lgkmcnt(3)
v_mfma_f32_16x16x32_bf16 v[196:199], v[72:75], v[228:231], v[196:199]
v_mfma_f32_16x16x32_bf16 v[200:203], v[104:107], v[228:231], v[200:203]
v_mfma_f32_16x16x32_bf16 v[204:207], v[136:139], v[228:231], v[204:207]
v_mfma_f32_16x16x32_bf16 v[208:211], v[168:171], v[228:231], v[208:211]
ds_read_b128 v[228:231], v241 offset:1088
s_waitcnt lgkmcnt(3)
v_mfma_f32_16x16x32_bf16 v[196:199], v[68:71], v[232:235], v[196:199]
v_mfma_f32_16x16x32_bf16 v[200:203], v[100:103], v[232:235], v[200:203]
v_mfma_f32_16x16x32_bf16 v[204:207], v[132:135], v[232:235], v[204:207]
v_mfma_f32_16x16x32_bf16 v[208:211], v[164:167], v[232:235], v[208:211]
ds_read_b128 v[232:235], v241 offset:1152
s_waitcnt lgkmcnt(3)
v_mfma_f32_16x16x32_bf16 v[196:199], v[64:67], v[236:239], v[196:199]
v_mfma_f32_16x16x32_bf16 v[200:203], v[96:99], v[236:239], v[200:203]
v_mfma_f32_16x16x32_bf16 v[204:207], v[128:131], v[236:239], v[204:207]
v_mfma_f32_16x16x32_bf16 v[208:211], v[160:163], v[236:239], v[208:211]
ds_read_b128 v[236:239], v241 offset:1216
s_waitcnt lgkmcnt(3)
v_mfma_f32_16x16x32_bf16 v[200:203], v[92:95], v[224:227], v[200:203]
v_mfma_f32_16x16x32_bf16 v[204:207], v[124:127], v[224:227], v[204:207]
v_mfma_f32_16x16x32_bf16 v[208:211], v[156:159], v[224:227], v[208:211]
v_mfma_f32_16x16x32_bf16 v[212:215], v[188:191], v[224:227], v[212:215]
ds_read_b128 v[224:227], v241 offset:1280
s_waitcnt lgkmcnt(3)
v_mfma_f32_16x16x32_bf16 v[200:203], v[88:91], v[228:231], v[200:203]
v_mfma_f32_16x16x32_bf16 v[204:207], v[120:123], v[228:231], v[204:207]
v_mfma_f32_16x16x32_bf16 v[208:211], v[152:155], v[228:231], v[208:211]
v_mfma_f32_16x16x32_bf16 v[212:215], v[184:187], v[228:231], v[212:215]
ds_read_b128 v[228:231], v241 offset:1344
s_waitcnt lgkmcnt(3)
v_mfma_f32_16x16x32_bf16 v[200:203], v[84:87], v[232:235], v[200:203]
v_mfma_f32_16x16x32_bf16 v[204:207], v[116:119], v[232:235], v[204:207]
v_mfma_f32_16x16x32_bf16 v[208:211], v[148:151], v[232:235], v[208:211]
v_mfma_f32_16x16x32_bf16 v[212:215], v[180:183], v[232:235], v[212:215]
ds_read_b128 v[232:235], v241 offset:1408
s_waitcnt lgkmcnt(3)
v_mfma_f32_16x16x32_bf16 v[200:203], v[80:83], v[236:239], v[200:203]
v_mfma_f32_16x16x32_bf16 v[204:207], v[112:115], v[236:239], v[204:207]
v_mfma_f32_16x16x32_bf16 v[208:211], v[144:147], v[236:239], v[208:211]
v_mfma_f32_16x16x32_bf16 v[212:215], v[176:179], v[236:239], v[212:215]
ds_read_b128 v[236:239], v241 offset:1472
s_waitcnt lgkmcnt(3)
v_mfma_f32_16x16x32_bf16 v[200:203], v[76:79], v[224:227], v[200:203]
v_mfma_f32_16x16x32_bf16 v[204:207], v[108:111], v[224:227], v[204:207]
v_mfma_f32_16x16x32_bf16 v[208:211], v[140:143], v[224:227], v[208:211]
v_mfma_f32_16x16x32_bf16 v[212:215], v[172:175], v[224:227], v[212:215]
ds_read_b128 v[224:227], v241 offset:1536
s_waitcnt lgkmcnt(3)
v_mfma_f32_16x16x32_bf16 v[200:203], v[72:75], v[228:231], v[200:203]
v_mfma_f32_16x16x32_bf16 v[204:207], v[104:107], v[228:231], v[204:207]
v_mfma_f32_16x16x32_bf16 v[208:211], v[136:139], v[228:231], v[208:211]
v_mfma_f32_16x16x32_bf16 v[212:215], v[168:171], v[228:231], v[212:215]
ds_read_b128 v[228:231], v241 offset:1600
s_waitcnt lgkmcnt(3)
v_mfma_f32_16x16x32_bf16 v[200:203], v[68:71], v[232:235], v[200:203]
v_mfma_f32_16x16x32_bf16 v[204:207], v[100:103], v[232:235], v[204:207]
v_mfma_f32_16x16x32_bf16 v[208:211], v[132:135], v[232:235], v[208:211]
v_mfma_f32_16x16x32_bf16 v[212:215], v[164:167], v[232:235], v[212:215]
ds_read_b128 v[232:235], v241 offset:1664
s_waitcnt lgkmcnt(3)
v_mfma_f32_16x16x32_bf16 v[200:203], v[64:67], v[236:239], v[200:203]
v_mfma_f32_16x16x32_bf16 v[204:207], v[96:99], v[236:239], v[204:207]
v_mfma_f32_16x16x32_bf16 v[208:211], v[128:131], v[236:239], v[208:211]
v_mfma_f32_16x16x32_bf16 v[212:215], v[160:163], v[236:239], v[212:215]
ds_read_b128 v[236:239], v241 offset:1728
s_waitcnt lgkmcnt(3)
v_mfma_f32_16x16x32_bf16 v[204:207], v[92:95], v[224:227], v[204:207]
v_mfma_f32_16x16x32_bf16 v[208:211], v[124:127], v[224:227], v[208:211]
v_mfma_f32_16x16x32_bf16 v[212:215], v[156:159], v[224:227], v[212:215]
v_mfma_f32_16x16x32_bf16 v[216:219], v[188:191], v[224:227], v[216:219]
ds_read_b128 v[224:227], v241 offset:1792
s_waitcnt lgkmcnt(3)
v_mfma_f32_16x16x32_bf16 v[204:207], v[88:91], v[228:231], v[204:207]
v_mfma_f32_16x16x32_bf16 v[208:211], v[120:123], v[228:231], v[208:211]
v_mfma_f32_16x16x32_bf16 v[212:215], v[152:155], v[228:231], v[212:215]
v_mfma_f32_16x16x32_bf16 v[216:219], v[184:187], v[228:231], v[216:219]
ds_read_b128 v[228:231], v241 offset:1856
s_waitcnt lgkmcnt(3)
v_mfma_f32_16x16x32_bf16 v[204:207], v[84:87], v[232:235], v[204:207]
v_mfma_f32_16x16x32_bf16 v[208:211], v[116:119], v[232:235], v[208:211]
v_mfma_f32_16x16x32_bf16 v[212:215], v[148:151], v[232:235], v[212:215]
v_mfma_f32_16x16x32_bf16 v[216:219], v[180:183], v[232:235], v[216:219]
ds_read_b128 v[232:235], v241 offset:1920
s_waitcnt lgkmcnt(3)
v_mfma_f32_16x16x32_bf16 v[204:207], v[80:83], v[236:239], v[204:207]
v_mfma_f32_16x16x32_bf16 v[208:211], v[112:115], v[236:239], v[208:211]
v_mfma_f32_16x16x32_bf16 v[212:215], v[144:147], v[236:239], v[212:215]
v_mfma_f32_16x16x32_bf16 v[216:219], v[176:179], v[236:239], v[216:219]
ds_read_b128 v[236:239], v241 offset:1984
s_waitcnt lgkmcnt(3)
v_mfma_f32_16x16x32_bf16 v[204:207], v[76:79], v[224:227], v[204:207]
v_mfma_f32_16x16x32_bf16 v[208:211], v[108:111], v[224:227], v[208:211]
v_mfma_f32_16x16x32_bf16 v[212:215], v[140:143], v[224:227], v[212:215]
v_mfma_f32_16x16x32_bf16 v[216:219], v[172:175], v[224:227], v[216:219]
ds_read_b128 v[224:227], v241 offset:2048
s_waitcnt lgkmcnt(3)
v_mfma_f32_16x16x32_bf16 v[204:207], v[72:75], v[228:231], v[204:207]
v_mfma_f32_16x16x32_bf16 v[208:211], v[104:107], v[228:231], v[208:211]
v_mfma_f32_16x16x32_bf16 v[212:215], v[136:139], v[228:231], v[212:215]
v_mfma_f32_16x16x32_bf16 v[216:219], v[168:171], v[228:231], v[216:219]
ds_read_b128 v[228:231], v241 offset:2112
s_waitcnt lgkmcnt(3)
v_mfma_f32_16x16x32_bf16 v[204:207], v[68:71], v[232:235], v[204:207]
v_mfma_f32_16x16x32_bf16 v[208:211], v[100:103], v[232:235], v[208:211]
v_mfma_f32_16x16x32_bf16 v[212:215], v[132:135], v[232:235], v[212:215]
v_mfma_f32_16x16x32_bf16 v[216:219], v[164:167], v[232:235], v[216:219]
ds_read_b128 v[232:235], v241 offset:2176
s_waitcnt lgkmcnt(3)
v_mfma_f32_16x16x32_bf16 v[204:207], v[64:67], v[236:239], v[204:207]
v_mfma_f32_16x16x32_bf16 v[208:211], v[96:99], v[236:239], v[208:211]
v_mfma_f32_16x16x32_bf16 v[212:215], v[128:131], v[236:239], v[212:215]
v_mfma_f32_16x16x32_bf16 v[216:219], v[160:163], v[236:239], v[216:219]
ds_read_b128 v[236:239], v241 offset:2240
s_waitcnt lgkmcnt(3)
v_mfma_f32_16x16x32_bf16 v[208:211], v[92:95], v[224:227], v[208:211]
v_mfma_f32_16x16x32_bf16 v[212:215], v[124:127], v[224:227], v[212:215]
v_mfma_f32_16x16x32_bf16 v[216:219], v[156:159], v[224:227], v[216:219]
v_mfma_f32_16x16x32_bf16 v[220:223], v[188:191], v[224:227], v[220:223]
ds_read_b64_tr_b16 v[188:189], v240 offset:4040
ds_read_b64_tr_b16 v[190:191], v240 offset:4032
ds_read_b128 v[224:227], v241 offset:2304
s_waitcnt lgkmcnt(5)
v_mfma_f32_16x16x32_bf16 v[208:211], v[88:91], v[228:231], v[208:211]
v_mfma_f32_16x16x32_bf16 v[212:215], v[120:123], v[228:231], v[212:215]
v_mfma_f32_16x16x32_bf16 v[216:219], v[152:155], v[228:231], v[216:219]
v_mfma_f32_16x16x32_bf16 v[220:223], v[184:187], v[228:231], v[220:223]
ds_read_b64_tr_b16 v[184:185], v240 offset:3976
ds_read_b64_tr_b16 v[186:187], v240 offset:3968
ds_read_b128 v[228:231], v241 offset:2368
s_waitcnt lgkmcnt(7)
v_mfma_f32_16x16x32_bf16 v[208:211], v[84:87], v[232:235], v[208:211]
v_mfma_f32_16x16x32_bf16 v[212:215], v[116:119], v[232:235], v[212:215]
v_mfma_f32_16x16x32_bf16 v[216:219], v[148:151], v[232:235], v[216:219]
v_mfma_f32_16x16x32_bf16 v[220:223], v[180:183], v[232:235], v[220:223]
ds_read_b64_tr_b16 v[180:181], v240 offset:3912
ds_read_b64_tr_b16 v[182:183], v240 offset:3904
ds_read_b128 v[232:235], v241 offset:2432
s_waitcnt lgkmcnt(9)
v_mfma_f32_16x16x32_bf16 v[208:211], v[80:83], v[236:239], v[208:211]
v_mfma_f32_16x16x32_bf16 v[212:215], v[112:115], v[236:239], v[212:215]
v_mfma_f32_16x16x32_bf16 v[216:219], v[144:147], v[236:239], v[216:219]
v_mfma_f32_16x16x32_bf16 v[220:223], v[176:179], v[236:239], v[220:223]
ds_read_b64_tr_b16 v[176:177], v240 offset:3848
ds_read_b64_tr_b16 v[178:179], v240 offset:3840
ds_read_b128 v[236:239], v241 offset:2496
s_waitcnt lgkmcnt(9)
v_mfma_f32_16x16x32_bf16 v[208:211], v[76:79], v[224:227], v[208:211]
v_mfma_f32_16x16x32_bf16 v[212:215], v[108:111], v[224:227], v[212:215]
v_mfma_f32_16x16x32_bf16 v[216:219], v[140:143], v[224:227], v[216:219]
v_mfma_f32_16x16x32_bf16 v[220:223], v[172:175], v[224:227], v[220:223]
ds_read_b64_tr_b16 v[172:173], v240 offset:3784
ds_read_b64_tr_b16 v[174:175], v240 offset:3776
ds_read_b128 v[224:227], v241 offset:2560
s_waitcnt lgkmcnt(9)
v_mfma_f32_16x16x32_bf16 v[208:211], v[72:75], v[228:231], v[208:211]
v_mfma_f32_16x16x32_bf16 v[212:215], v[104:107], v[228:231], v[212:215]
v_mfma_f32_16x16x32_bf16 v[216:219], v[136:139], v[228:231], v[216:219]
v_mfma_f32_16x16x32_bf16 v[220:223], v[168:171], v[228:231], v[220:223]
ds_read_b64_tr_b16 v[168:169], v240 offset:3720
ds_read_b64_tr_b16 v[170:171], v240 offset:3712
ds_read_b128 v[228:231], v241 offset:2624
s_waitcnt lgkmcnt(9)
v_mfma_f32_16x16x32_bf16 v[208:211], v[68:71], v[232:235], v[208:211]
v_mfma_f32_16x16x32_bf16 v[212:215], v[100:103], v[232:235], v[212:215]
v_mfma_f32_16x16x32_bf16 v[216:219], v[132:135], v[232:235], v[216:219]
v_mfma_f32_16x16x32_bf16 v[220:223], v[164:167], v[232:235], v[220:223]
ds_read_b64_tr_b16 v[164:165], v240 offset:3656
ds_read_b64_tr_b16 v[166:167], v240 offset:3648
ds_read_b128 v[232:235], v241 offset:2688
s_waitcnt lgkmcnt(9)
v_mfma_f32_16x16x32_bf16 v[208:211], v[64:67], v[236:239], v[208:211]
v_mfma_f32_16x16x32_bf16 v[212:215], v[96:99], v[236:239], v[212:215]
v_mfma_f32_16x16x32_bf16 v[216:219], v[128:131], v[236:239], v[216:219]
v_mfma_f32_16x16x32_bf16 v[220:223], v[160:163], v[236:239], v[220:223]
ds_read_b64_tr_b16 v[160:161], v240 offset:3592
ds_read_b64_tr_b16 v[162:163], v240 offset:3584
ds_read_b128 v[236:239], v241 offset:2752
s_waitcnt lgkmcnt(9)
v_mfma_f32_16x16x32_bf16 v[212:215], v[92:95], v[224:227], v[212:215]
v_mfma_f32_16x16x32_bf16 v[216:219], v[124:127], v[224:227], v[216:219]
v_mfma_f32_16x16x32_bf16 v[220:223], v[156:159], v[224:227], v[220:223]
ds_read_b64_tr_b16 v[156:157], v240 offset:3528
ds_read_b64_tr_b16 v[158:159], v240 offset:3520
ds_read_b128 v[224:227], v241 offset:2816
s_waitcnt lgkmcnt(9)
v_mfma_f32_16x16x32_bf16 v[212:215], v[88:91], v[228:231], v[212:215]
v_mfma_f32_16x16x32_bf16 v[216:219], v[120:123], v[228:231], v[216:219]
v_mfma_f32_16x16x32_bf16 v[220:223], v[152:155], v[228:231], v[220:223]
ds_read_b64_tr_b16 v[152:153], v240 offset:3464
ds_read_b64_tr_b16 v[154:155], v240 offset:3456
ds_read_b128 v[228:231], v241 offset:2880
s_waitcnt lgkmcnt(9)
v_mfma_f32_16x16x32_bf16 v[212:215], v[84:87], v[232:235], v[212:215]
v_mfma_f32_16x16x32_bf16 v[216:219], v[116:119], v[232:235], v[216:219]
v_mfma_f32_16x16x32_bf16 v[220:223], v[148:151], v[232:235], v[220:223]
ds_read_b64_tr_b16 v[148:149], v240 offset:3400
ds_read_b64_tr_b16 v[150:151], v240 offset:3392
ds_read_b128 v[232:235], v241 offset:2944
s_waitcnt lgkmcnt(9)
v_mfma_f32_16x16x32_bf16 v[212:215], v[80:83], v[236:239], v[212:215]
v_mfma_f32_16x16x32_bf16 v[216:219], v[112:115], v[236:239], v[216:219]
v_mfma_f32_16x16x32_bf16 v[220:223], v[144:147], v[236:239], v[220:223]
ds_read_b64_tr_b16 v[144:145], v240 offset:3336
ds_read_b64_tr_b16 v[146:147], v240 offset:3328
ds_read_b128 v[236:239], v241 offset:3008
s_waitcnt lgkmcnt(9)
v_mfma_f32_16x16x32_bf16 v[212:215], v[76:79], v[224:227], v[212:215]
v_mfma_f32_16x16x32_bf16 v[216:219], v[108:111], v[224:227], v[216:219]
v_mfma_f32_16x16x32_bf16 v[220:223], v[140:143], v[224:227], v[220:223]
ds_read_b64_tr_b16 v[140:141], v240 offset:3272
ds_read_b64_tr_b16 v[142:143], v240 offset:3264
ds_read_b128 v[224:227], v241 offset:3072
s_waitcnt lgkmcnt(9)
v_mfma_f32_16x16x32_bf16 v[212:215], v[72:75], v[228:231], v[212:215]
v_mfma_f32_16x16x32_bf16 v[216:219], v[104:107], v[228:231], v[216:219]
v_mfma_f32_16x16x32_bf16 v[220:223], v[136:139], v[228:231], v[220:223]
ds_read_b64_tr_b16 v[136:137], v240 offset:3208
ds_read_b64_tr_b16 v[138:139], v240 offset:3200
ds_read_b128 v[228:231], v241 offset:3136
s_waitcnt lgkmcnt(9)
v_mfma_f32_16x16x32_bf16 v[212:215], v[68:71], v[232:235], v[212:215]
v_mfma_f32_16x16x32_bf16 v[216:219], v[100:103], v[232:235], v[216:219]
v_mfma_f32_16x16x32_bf16 v[220:223], v[132:135], v[232:235], v[220:223]
ds_read_b64_tr_b16 v[132:133], v240 offset:3144
ds_read_b64_tr_b16 v[134:135], v240 offset:3136
ds_read_b128 v[232:235], v241 offset:3200
s_waitcnt lgkmcnt(9)
v_mfma_f32_16x16x32_bf16 v[212:215], v[64:67], v[236:239], v[212:215]
v_mfma_f32_16x16x32_bf16 v[216:219], v[96:99], v[236:239], v[216:219]
v_mfma_f32_16x16x32_bf16 v[220:223], v[128:131], v[236:239], v[220:223]
ds_read_b64_tr_b16 v[128:129], v240 offset:3080
ds_read_b64_tr_b16 v[130:131], v240 offset:3072
ds_read_b128 v[236:239], v241 offset:3264
s_waitcnt lgkmcnt(9)
v_mfma_f32_16x16x32_bf16 v[216:219], v[92:95], v[224:227], v[216:219]
v_mfma_f32_16x16x32_bf16 v[220:223], v[124:127], v[224:227], v[220:223]
ds_read_b64_tr_b16 v[124:125], v240 offset:3016
ds_read_b64_tr_b16 v[126:127], v240 offset:3008
ds_read_b128 v[224:227], v241 offset:3328
s_waitcnt lgkmcnt(9)
v_mfma_f32_16x16x32_bf16 v[216:219], v[88:91], v[228:231], v[216:219]
v_mfma_f32_16x16x32_bf16 v[220:223], v[120:123], v[228:231], v[220:223]
ds_read_b64_tr_b16 v[120:121], v240 offset:2952
ds_read_b64_tr_b16 v[122:123], v240 offset:2944
ds_read_b128 v[228:231], v241 offset:3392
s_waitcnt lgkmcnt(9)
v_mfma_f32_16x16x32_bf16 v[216:219], v[84:87], v[232:235], v[216:219]
v_mfma_f32_16x16x32_bf16 v[220:223], v[116:119], v[232:235], v[220:223]
ds_read_b64_tr_b16 v[116:117], v240 offset:2888
ds_read_b64_tr_b16 v[118:119], v240 offset:2880
ds_read_b128 v[232:235], v241 offset:3456
s_waitcnt lgkmcnt(9)
v_mfma_f32_16x16x32_bf16 v[216:219], v[80:83], v[236:239], v[216:219]
v_mfma_f32_16x16x32_bf16 v[220:223], v[112:115], v[236:239], v[220:223]
ds_read_b64_tr_b16 v[112:113], v240 offset:2824
ds_read_b64_tr_b16 v[114:115], v240 offset:2816
ds_read_b128 v[236:239], v241 offset:3520
s_waitcnt lgkmcnt(9)
v_mfma_f32_16x16x32_bf16 v[216:219], v[76:79], v[224:227], v[216:219]
v_mfma_f32_16x16x32_bf16 v[220:223], v[108:111], v[224:227], v[220:223]
ds_read_b64_tr_b16 v[108:109], v240 offset:2760
ds_read_b64_tr_b16 v[110:111], v240 offset:2752
ds_read_b128 v[224:227], v241 offset:3584
s_waitcnt lgkmcnt(9)
v_mfma_f32_16x16x32_bf16 v[216:219], v[72:75], v[228:231], v[216:219]
v_mfma_f32_16x16x32_bf16 v[220:223], v[104:107], v[228:231], v[220:223]
ds_read_b64_tr_b16 v[104:105], v240 offset:2696
ds_read_b64_tr_b16 v[106:107], v240 offset:2688
ds_read_b128 v[228:231], v241 offset:3648
s_waitcnt lgkmcnt(9)
v_mfma_f32_16x16x32_bf16 v[216:219], v[68:71], v[232:235], v[216:219]
v_mfma_f32_16x16x32_bf16 v[220:223], v[100:103], v[232:235], v[220:223]
ds_read_b64_tr_b16 v[100:101], v240 offset:2632
ds_read_b64_tr_b16 v[102:103], v240 offset:2624
ds_read_b128 v[232:235], v241 offset:3712
s_waitcnt lgkmcnt(9)
v_mfma_f32_16x16x32_bf16 v[216:219], v[64:67], v[236:239], v[216:219]
v_mfma_f32_16x16x32_bf16 v[220:223], v[96:99], v[236:239], v[220:223]
ds_read_b64_tr_b16 v[96:97], v240 offset:2568
ds_read_b64_tr_b16 v[98:99], v240 offset:2560
ds_read_b128 v[236:239], v241 offset:3776
s_waitcnt lgkmcnt(9)
v_mfma_f32_16x16x32_bf16 v[220:223], v[92:95], v[224:227], v[220:223]
ds_read_b64_tr_b16 v[92:93], v240 offset:2504
ds_read_b64_tr_b16 v[94:95], v240 offset:2496
ds_read_b128 v[224:227], v241 offset:3840
s_waitcnt lgkmcnt(9)
v_mfma_f32_16x16x32_bf16 v[220:223], v[88:91], v[228:231], v[220:223]
ds_read_b64_tr_b16 v[88:89], v240 offset:2440
ds_read_b64_tr_b16 v[90:91], v240 offset:2432
ds_read_b128 v[228:231], v241 offset:3904
s_waitcnt lgkmcnt(9)
v_mfma_f32_16x16x32_bf16 v[220:223], v[84:87], v[232:235], v[220:223]
ds_read_b64_tr_b16 v[84:85], v240 offset:2376
ds_read_b64_tr_b16 v[86:87], v240 offset:2368
ds_read_b128 v[232:235], v241 offset:3968
s_waitcnt lgkmcnt(9)
v_mfma_f32_16x16x32_bf16 v[220:223], v[80:83], v[236:239], v[220:223]
ds_read_b64_tr_b16 v[80:81], v240 offset:2312
ds_read_b64_tr_b16 v[82:83], v240 offset:2304
ds_read_b128 v[236:239], v241 offset:4032
s_waitcnt lgkmcnt(9)
v_mfma_f32_16x16x32_bf16 v[220:223], v[76:79], v[224:227], v[220:223]
ds_read_b64_tr_b16 v[76:77], v240 offset:2248
ds_read_b64_tr_b16 v[78:79], v240 offset:2240
s_waitcnt lgkmcnt(8)
v_mfma_f32_16x16x32_bf16 v[220:223], v[72:75], v[228:231], v[220:223]
ds_read_b64_tr_b16 v[72:73], v240 offset:2184
ds_read_b64_tr_b16 v[74:75], v240 offset:2176
s_waitcnt lgkmcnt(7)
v_mfma_f32_16x16x32_bf16 v[220:223], v[68:71], v[232:235], v[220:223]
ds_read_b64_tr_b16 v[68:69], v240 offset:2120
ds_read_b64_tr_b16 v[70:71], v240 offset:2112
s_waitcnt lgkmcnt(6)
v_mfma_f32_16x16x32_bf16 v[220:223], v[64:67], v[236:239], v[220:223]
ds_read_b64_tr_b16 v[64:65], v240 offset:2056
ds_read_b64_tr_b16 v[66:67], v240 offset:2048
ds_read_b128 v[224:227], v241 offset:0
ds_read_b128 v[228:231], v241 offset:64
ds_read_b128 v[232:235], v241 offset:128
ds_read_b128 v[236:239], v241 offset:192
s_waitcnt lgkmcnt(3)
v_mfma_f32_16x16x32_bf16 v[208:211], v[92:95], v[224:227], v[208:211]
v_mfma_f32_16x16x32_bf16 v[212:215], v[124:127], v[224:227], v[212:215]
v_mfma_f32_16x16x32_bf16 v[216:219], v[156:159], v[224:227], v[216:219]
v_mfma_f32_16x16x32_bf16 v[220:223], v[188:191], v[224:227], v[220:223]
ds_read_b128 v[224:227], v241 offset:256
s_waitcnt lgkmcnt(3)
v_mfma_f32_16x16x32_bf16 v[208:211], v[88:91], v[228:231], v[208:211]
v_mfma_f32_16x16x32_bf16 v[212:215], v[120:123], v[228:231], v[212:215]
v_mfma_f32_16x16x32_bf16 v[216:219], v[152:155], v[228:231], v[216:219]
v_mfma_f32_16x16x32_bf16 v[220:223], v[184:187], v[228:231], v[220:223]
ds_read_b128 v[228:231], v241 offset:320
s_waitcnt lgkmcnt(3)
v_mfma_f32_16x16x32_bf16 v[208:211], v[84:87], v[232:235], v[208:211]
v_mfma_f32_16x16x32_bf16 v[212:215], v[116:119], v[232:235], v[212:215]
v_mfma_f32_16x16x32_bf16 v[216:219], v[148:151], v[232:235], v[216:219]
v_mfma_f32_16x16x32_bf16 v[220:223], v[180:183], v[232:235], v[220:223]
ds_read_b128 v[232:235], v241 offset:384
s_waitcnt lgkmcnt(3)
v_mfma_f32_16x16x32_bf16 v[208:211], v[80:83], v[236:239], v[208:211]
v_mfma_f32_16x16x32_bf16 v[212:215], v[112:115], v[236:239], v[212:215]
v_mfma_f32_16x16x32_bf16 v[216:219], v[144:147], v[236:239], v[216:219]
v_mfma_f32_16x16x32_bf16 v[220:223], v[176:179], v[236:239], v[220:223]
ds_read_b128 v[236:239], v241 offset:448
s_waitcnt lgkmcnt(3)
v_mfma_f32_16x16x32_bf16 v[208:211], v[76:79], v[224:227], v[208:211]
v_mfma_f32_16x16x32_bf16 v[212:215], v[108:111], v[224:227], v[212:215]
v_mfma_f32_16x16x32_bf16 v[216:219], v[140:143], v[224:227], v[216:219]
v_mfma_f32_16x16x32_bf16 v[220:223], v[172:175], v[224:227], v[220:223]
ds_read_b128 v[224:227], v241 offset:512
s_waitcnt lgkmcnt(3)
v_mfma_f32_16x16x32_bf16 v[208:211], v[72:75], v[228:231], v[208:211]
v_mfma_f32_16x16x32_bf16 v[212:215], v[104:107], v[228:231], v[212:215]
v_mfma_f32_16x16x32_bf16 v[216:219], v[136:139], v[228:231], v[216:219]
v_mfma_f32_16x16x32_bf16 v[220:223], v[168:171], v[228:231], v[220:223]
ds_read_b128 v[228:231], v241 offset:576
s_waitcnt lgkmcnt(3)
v_mfma_f32_16x16x32_bf16 v[208:211], v[68:71], v[232:235], v[208:211]
v_mfma_f32_16x16x32_bf16 v[212:215], v[100:103], v[232:235], v[212:215]
v_mfma_f32_16x16x32_bf16 v[216:219], v[132:135], v[232:235], v[216:219]
v_mfma_f32_16x16x32_bf16 v[220:223], v[164:167], v[232:235], v[220:223]
ds_read_b128 v[232:235], v241 offset:640
s_waitcnt lgkmcnt(3)
v_mfma_f32_16x16x32_bf16 v[208:211], v[64:67], v[236:239], v[208:211]
v_mfma_f32_16x16x32_bf16 v[212:215], v[96:99], v[236:239], v[212:215]
v_mfma_f32_16x16x32_bf16 v[216:219], v[128:131], v[236:239], v[216:219]
v_mfma_f32_16x16x32_bf16 v[220:223], v[160:163], v[236:239], v[220:223]
ds_read_b128 v[236:239], v241 offset:704
s_waitcnt lgkmcnt(3)
v_mfma_f32_16x16x32_bf16 v[212:215], v[92:95], v[224:227], v[212:215]
v_mfma_f32_16x16x32_bf16 v[216:219], v[124:127], v[224:227], v[216:219]
v_mfma_f32_16x16x32_bf16 v[220:223], v[156:159], v[224:227], v[220:223]
ds_read_b128 v[224:227], v241 offset:768
s_waitcnt lgkmcnt(3)
v_mfma_f32_16x16x32_bf16 v[212:215], v[88:91], v[228:231], v[212:215]
v_mfma_f32_16x16x32_bf16 v[216:219], v[120:123], v[228:231], v[216:219]
v_mfma_f32_16x16x32_bf16 v[220:223], v[152:155], v[228:231], v[220:223]
ds_read_b128 v[228:231], v241 offset:832
s_waitcnt lgkmcnt(3)
v_mfma_f32_16x16x32_bf16 v[212:215], v[84:87], v[232:235], v[212:215]
v_mfma_f32_16x16x32_bf16 v[216:219], v[116:119], v[232:235], v[216:219]
v_mfma_f32_16x16x32_bf16 v[220:223], v[148:151], v[232:235], v[220:223]
ds_read_b128 v[232:235], v241 offset:896
s_waitcnt lgkmcnt(3)
v_mfma_f32_16x16x32_bf16 v[212:215], v[80:83], v[236:239], v[212:215]
v_mfma_f32_16x16x32_bf16 v[216:219], v[112:115], v[236:239], v[216:219]
v_mfma_f32_16x16x32_bf16 v[220:223], v[144:147], v[236:239], v[220:223]
ds_read_b128 v[236:239], v241 offset:960
s_waitcnt lgkmcnt(3)
v_mfma_f32_16x16x32_bf16 v[212:215], v[76:79], v[224:227], v[212:215]
v_mfma_f32_16x16x32_bf16 v[216:219], v[108:111], v[224:227], v[216:219]
v_mfma_f32_16x16x32_bf16 v[220:223], v[140:143], v[224:227], v[220:223]
ds_read_b128 v[224:227], v241 offset:1024
s_waitcnt lgkmcnt(3)
v_mfma_f32_16x16x32_bf16 v[212:215], v[72:75], v[228:231], v[212:215]
v_mfma_f32_16x16x32_bf16 v[216:219], v[104:107], v[228:231], v[216:219]
v_mfma_f32_16x16x32_bf16 v[220:223], v[136:139], v[228:231], v[220:223]
ds_read_b128 v[228:231], v241 offset:1088
s_waitcnt lgkmcnt(3)
v_mfma_f32_16x16x32_bf16 v[212:215], v[68:71], v[232:235], v[212:215]
v_mfma_f32_16x16x32_bf16 v[216:219], v[100:103], v[232:235], v[216:219]
v_mfma_f32_16x16x32_bf16 v[220:223], v[132:135], v[232:235], v[220:223]
ds_read_b128 v[232:235], v241 offset:1152
s_waitcnt lgkmcnt(3)
v_mfma_f32_16x16x32_bf16 v[212:215], v[64:67], v[236:239], v[212:215]
v_mfma_f32_16x16x32_bf16 v[216:219], v[96:99], v[236:239], v[216:219]
v_mfma_f32_16x16x32_bf16 v[220:223], v[128:131], v[236:239], v[220:223]
ds_read_b128 v[236:239], v241 offset:1216
s_waitcnt lgkmcnt(3)
v_mfma_f32_16x16x32_bf16 v[216:219], v[92:95], v[224:227], v[216:219]
v_mfma_f32_16x16x32_bf16 v[220:223], v[124:127], v[224:227], v[220:223]
ds_read_b128 v[224:227], v241 offset:1280
s_waitcnt lgkmcnt(3)
v_mfma_f32_16x16x32_bf16 v[216:219], v[88:91], v[228:231], v[216:219]
v_mfma_f32_16x16x32_bf16 v[220:223], v[120:123], v[228:231], v[220:223]
ds_read_b128 v[228:231], v241 offset:1344
s_waitcnt lgkmcnt(3)
v_mfma_f32_16x16x32_bf16 v[216:219], v[84:87], v[232:235], v[216:219]
v_mfma_f32_16x16x32_bf16 v[220:223], v[116:119], v[232:235], v[220:223]
ds_read_b128 v[232:235], v241 offset:1408
s_waitcnt lgkmcnt(3)
v_mfma_f32_16x16x32_bf16 v[216:219], v[80:83], v[236:239], v[216:219]
v_mfma_f32_16x16x32_bf16 v[220:223], v[112:115], v[236:239], v[220:223]
ds_read_b128 v[236:239], v241 offset:1472
s_waitcnt lgkmcnt(3)
v_mfma_f32_16x16x32_bf16 v[216:219], v[76:79], v[224:227], v[216:219]
v_mfma_f32_16x16x32_bf16 v[220:223], v[108:111], v[224:227], v[220:223]
ds_read_b128 v[224:227], v241 offset:1536
s_waitcnt lgkmcnt(3)
v_mfma_f32_16x16x32_bf16 v[216:219], v[72:75], v[228:231], v[216:219]
v_mfma_f32_16x16x32_bf16 v[220:223], v[104:107], v[228:231], v[220:223]
ds_read_b128 v[228:231], v241 offset:1600
s_waitcnt lgkmcnt(3)
v_mfma_f32_16x16x32_bf16 v[216:219], v[68:71], v[232:235], v[216:219]
v_mfma_f32_16x16x32_bf16 v[220:223], v[100:103], v[232:235], v[220:223]
ds_read_b128 v[232:235], v241 offset:1664
s_waitcnt lgkmcnt(3)
v_mfma_f32_16x16x32_bf16 v[216:219], v[64:67], v[236:239], v[216:219]
v_mfma_f32_16x16x32_bf16 v[220:223], v[96:99], v[236:239], v[220:223]
ds_read_b128 v[236:239], v241 offset:1728
s_waitcnt lgkmcnt(3)
v_mfma_f32_16x16x32_bf16 v[220:223], v[92:95], v[224:227], v[220:223]
ds_read_b128 v[224:227], v241 offset:1792
s_waitcnt lgkmcnt(3)
v_mfma_f32_16x16x32_bf16 v[220:223], v[88:91], v[228:231], v[220:223]
ds_read_b128 v[228:231], v241 offset:1856
s_waitcnt lgkmcnt(3)
v_mfma_f32_16x16x32_bf16 v[220:223], v[84:87], v[232:235], v[220:223]
ds_read_b128 v[232:235], v241 offset:1920
s_waitcnt lgkmcnt(3)
v_mfma_f32_16x16x32_bf16 v[220:223], v[80:83], v[236:239], v[220:223]
ds_read_b128 v[236:239], v241 offset:1984
s_waitcnt lgkmcnt(3)
v_mfma_f32_16x16x32_bf16 v[220:223], v[76:79], v[224:227], v[220:223]
s_waitcnt lgkmcnt(2)
v_mfma_f32_16x16x32_bf16 v[220:223], v[72:75], v[228:231], v[220:223]
s_waitcnt lgkmcnt(1)
v_mfma_f32_16x16x32_bf16 v[220:223], v[68:71], v[232:235], v[220:223]
s_waitcnt lgkmcnt(0)
v_mfma_f32_16x16x32_bf16 v[220:223], v[64:67], v[236:239], v[220:223]
ds_read_b64 v[64:65], v246 offset:0
ds_read_b64 v[66:67], v246 offset:512
ds_read_b64 v[68:69], v246 offset:1024
ds_read_b64 v[70:71], v246 offset:1536
ds_read_b64 v[72:73], v246 offset:2048
ds_read_b64 v[74:75], v246 offset:2560
ds_read_b64 v[76:77], v246 offset:3072
ds_read_b64 v[78:79], v246 offset:3584
v_lshlrev_b32 v243, 16, v243
s_mov_b32 s48, 0xffff0000
s_waitcnt lgkmcnt(7)
v_lshlrev_b32 v96, 16, v64
v_and_b32 v97, s48, v64
v_lshlrev_b32 v98, 16, v65
v_and_b32 v99, s48, v65
v_fma_f32 v96, v243, v96, v192
v_fma_f32 v97, v243, v97, v193
v_fma_f32 v98, v243, v98, v194
v_fma_f32 v99, v243, v99, v195
v_cvt_pk_bf16_f32 v100, v96, v97
v_cvt_pk_bf16_f32 v101, v98, v99
s_add_u32 s47, s46, 0
buffer_store_dwordx2 v[100:101], v245, s[36:39], s47 offen sc1
s_waitcnt lgkmcnt(6)
v_lshlrev_b32 v104, 16, v66
v_and_b32 v105, s48, v66
v_lshlrev_b32 v106, 16, v67
v_and_b32 v107, s48, v67
v_fma_f32 v104, v243, v104, v196
v_fma_f32 v105, v243, v105, v197
v_fma_f32 v106, v243, v106, v198
v_fma_f32 v107, v243, v107, v199
v_cvt_pk_bf16_f32 v108, v104, v105
v_cvt_pk_bf16_f32 v109, v106, v107
s_add_u32 s47, s46, 512
buffer_store_dwordx2 v[108:109], v245, s[36:39], s47 offen sc1
s_waitcnt lgkmcnt(5)
v_lshlrev_b32 v112, 16, v68
v_and_b32 v113, s48, v68
v_lshlrev_b32 v114, 16, v69
v_and_b32 v115, s48, v69
v_fma_f32 v112, v243, v112, v200
v_fma_f32 v113, v243, v113, v201
v_fma_f32 v114, v243, v114, v202
v_fma_f32 v115, v243, v115, v203
v_cvt_pk_bf16_f32 v116, v112, v113
v_cvt_pk_bf16_f32 v117, v114, v115
s_add_u32 s47, s46, 1024
buffer_store_dwordx2 v[116:117], v245, s[36:39], s47 offen sc1
s_waitcnt lgkmcnt(4)
v_lshlrev_b32 v96, 16, v70
v_and_b32 v97, s48, v70
v_lshlrev_b32 v98, 16, v71
v_and_b32 v99, s48, v71
v_fma_f32 v96, v243, v96, v204
v_fma_f32 v97, v243, v97, v205
v_fma_f32 v98, v243, v98, v206
v_fma_f32 v99, v243, v99, v207
v_cvt_pk_bf16_f32 v100, v96, v97
v_cvt_pk_bf16_f32 v101, v98, v99
s_add_u32 s47, s46, 1536
buffer_store_dwordx2 v[100:101], v245, s[36:39], s47 offen sc1
s_waitcnt lgkmcnt(3)
v_lshlrev_b32 v104, 16, v72
v_and_b32 v105, s48, v72
v_lshlrev_b32 v106, 16, v73
v_and_b32 v107, s48, v73
v_fma_f32 v104, v243, v104, v208
v_fma_f32 v105, v243, v105, v209
v_fma_f32 v106, v243, v106, v210
v_fma_f32 v107, v243, v107, v211
v_cvt_pk_bf16_f32 v108, v104, v105
v_cvt_pk_bf16_f32 v109, v106, v107
s_add_u32 s47, s46, 2048
buffer_store_dwordx2 v[108:109], v245, s[36:39], s47 offen sc1
s_waitcnt lgkmcnt(2)
v_lshlrev_b32 v112, 16, v74
v_and_b32 v113, s48, v74
v_lshlrev_b32 v114, 16, v75
v_and_b32 v115, s48, v75
v_fma_f32 v112, v243, v112, v212
v_fma_f32 v113, v243, v113, v213
v_fma_f32 v114, v243, v114, v214
v_fma_f32 v115, v243, v115, v215
v_cvt_pk_bf16_f32 v116, v112, v113
v_cvt_pk_bf16_f32 v117, v114, v115
s_add_u32 s47, s46, 2560
buffer_store_dwordx2 v[116:117], v245, s[36:39], s47 offen sc1
s_waitcnt lgkmcnt(1)
v_lshlrev_b32 v96, 16, v76
v_and_b32 v97, s48, v76
v_lshlrev_b32 v98, 16, v77
v_and_b32 v99, s48, v77
v_fma_f32 v96, v243, v96, v216
v_fma_f32 v97, v243, v97, v217
v_fma_f32 v98, v243, v98, v218
v_fma_f32 v99, v243, v99, v219
v_cvt_pk_bf16_f32 v100, v96, v97
v_cvt_pk_bf16_f32 v101, v98, v99
s_add_u32 s47, s46, 3072
buffer_store_dwordx2 v[100:101], v245, s[36:39], s47 offen sc1
s_waitcnt lgkmcnt(0)
v_lshlrev_b32 v104, 16, v78
v_and_b32 v105, s48, v78
v_lshlrev_b32 v106, 16, v79
v_and_b32 v107, s48, v79
v_fma_f32 v104, v243, v104, v220
v_fma_f32 v105, v243, v105, v221
v_fma_f32 v106, v243, v106, v222
v_fma_f32 v107, v243, v107, v223
v_cvt_pk_bf16_f32 v108, v104, v105
v_cvt_pk_bf16_f32 v109, v106, v107
s_add_u32 s47, s46, 3584
buffer_store_dwordx2 v[108:109], v245, s[36:39], s47 offen sc1
s_lshl_b32 s47, s40, 2
s_add_u32 s47, s47, 4096
v_mov_b32 v250, 0
v_mov_b32 v251, s58
s_waitcnt vmcnt(0)
s_mov_b64 exec, 1
buffer_store_dword v251, v250, s[8:11], s47 offen sc1
s_mov_b64 exec, -1
s_endpgm
L_taskA:
s_mov_b32 s43, 71424
s_mul_i32 s7, s5, 24
s_add_u32 s7, s7, s6
s_lshr_b32 s40, s7, 2
s_and_b32 s41, s7, 3
s_load_dwordx2 s[84:85], s[0:1], 96
v_and_b32 v240, 31, v1
v_mul_u32_u24 v240, 1280, v240
v_lshrrev_b32 v241, 5, v1
v_lshl_add_u32 v240, v241, 7, v240
s_mul_i32 s92, s40, 40960
s_mul_i32 s93, s41, 320
s_add_u32 s92, s92, s93
s_waitcnt lgkmcnt(0)
s_mov_b32 s86, 0x1e0000
s_mov_b32 s87, 0x20000
buffer_load_dword v243, v240, s[84:87], s92 offen
buffer_load_dword v244, v240, s[84:87], s92 offen offset:256
s_mov_b32 s42, s6
s_and_b32 s40, s5, 3
s_mul_i32 s40, s40, 40
s_add_u32 s7, s42, s40
s_mul_i32 s40, s7, 6554
s_lshr_b32 s40, s40, 16
s_mul_i32 s41, s40, 10
s_sub_u32 s41, s7, s41
s_lshr_b32 s3, s5, 2
s_lshl_b32 s3, s3, 4
s_add_u32 s40, s40, s3
s_load_dwordx2 s[8:9], s[0:1], 0
s_load_dwordx2 s[32:33], s[0:1], 128
s_load_dwordx2 s[60:61], s[0:1], 120
v_lshrrev_b32 v2, 3, v1
v_mul_u32_u24 v2, 1280, v2
v_and_b32 v3, 7, v1
v_lshl_add_u32 v2, v3, 4, v2
s_mul_i32 s44, s40, 81920
s_lshl_b32 s45, s41, 7
s_add_u32 s44, s44, s45
v_mov_b32 v250, 0
s_waitcnt lgkmcnt(0)
s_mov_b32 s10, 0x280000
s_mov_b32 s11, 0x20000
s_add_u32 s36, s32, 0x7e0000
s_addc_u32 s37, s33, 0
s_mov_b32 s38, 0x280000
s_mov_b32 s39, 0x20000
s_add_u32 m0, s43, 0
s_nop 0
buffer_load_dwordx4 v2, s[8:11], s44 offen lds
s_add_u32 m0, s43, 1024
s_add_u32 s44, s44, 10240
buffer_load_dwordx4 v2, s[8:11], s44 offen lds
s_add_u32 m0, s43, 2048
s_add_u32 s44, s44, 10240
buffer_load_dwordx4 v2, s[8:11], s44 offen lds
s_add_u32 m0, s43, 3072
s_add_u32 s44, s44, 10240
buffer_load_dwordx4 v2, s[8:11], s44 offen lds
s_add_u32 m0, s43, 4096
s_add_u32 s44, s44, 10240
buffer_load_dwordx4 v2, s[8:11], s44 offen lds
s_add_u32 m0, s43, 5120
s_add_u32 s44, s44, 10240
buffer_load_dwordx4 v2, s[8:11], s44 offen lds
s_add_u32 m0, s43, 6144
s_add_u32 s44, s44, 10240
buffer_load_dwordx4 v2, s[8:11], s44 offen lds
s_add_u32 m0, s43, 7168
s_add_u32 s44, s44, 10240
buffer_load_dwordx4 v2, s[8:11], s44 offen lds
global_load_dword v251, v250, s[60:61] sc1
v_lshrrev_b32 v4, 4, v1
v_bfe_u32 v5, v1, 2, 2
v_lshl_add_u32 v5, v4, 3, v5
v_lshlrev_b32 v5, 7, v5
v_and_b32 v6, 3, v1
v_lshl_add_u32 v5, v6, 3, v5
v_add_u32 v5, s43, v5
s_add_u32 s48, s43, 8192
v_and_b32 v6, 15, v1
v_and_b32 v7, 7, v6
v_xor_b32 v7, v7, v4
v_xor_b32 v3, 0, v7
v_lshlrev_b32 v3, 4, v3
v_lshl_add_u32 v56, v6, 7, v3
v_add_u32 v56, s48, v56
v_xor_b32 v3, 4, v7
v_lshlrev_b32 v3, 4, v3
v_lshl_add_u32 v57, v6, 7, v3
v_add_u32 v57, s48, v57
v_lshrrev_b32 v6, 3, v1
v_and_b32 v7, 7, v1
v_xor_b32 v3, v6, v7
v_lshlrev_b32 v3, 4, v3
v_lshl_add_u32 v60, v6, 7, v3
v_add_u32 v60, s48, v60
v_lshlrev_b32 v7, 4, v7
v_lshl_add_u32 v6, v6, 12, v7
s_lshl_b32 s46, s41, 18
s_lshl_b32 s47, s40, 7
s_add_u32 s46, s46, s47
s_waitcnt vmcnt(1)
ds_read_b64_tr_b16 v[8:9], v5 offset:0
ds_read_b64_tr_b16 v[10:11], v5 offset:512
ds_read_b64_tr_b16 v[12:13], v5 offset:4096
ds_read_b64_tr_b16 v[14:15], v5 offset:4608
s_waitcnt lgkmcnt(2)
ds_write_b128 v56, v[8:11]
s_waitcnt lgkmcnt(1)
ds_write_b128 v57, v[12:15]
ds_read_b128 v[24:27], v60 offset:0
ds_read_b128 v[28:31], v60 offset:1024
s_add_u32 s47, s46, 0
s_waitcnt lgkmcnt(1)
buffer_store_dwordx4 v[24:27], v6, s[36:39], s47 offen sc1
s_add_u32 s47, s46, 32768
s_waitcnt lgkmcnt(0)
buffer_store_dwordx4 v[28:31], v6, s[36:39], s47 offen sc1
ds_read_b64_tr_b16 v[8:9], v5 offset:32
ds_read_b64_tr_b16 v[10:11], v5 offset:544
ds_read_b64_tr_b16 v[12:13], v5 offset:4128
ds_read_b64_tr_b16 v[14:15], v5 offset:4640
s_waitcnt lgkmcnt(2)
ds_write_b128 v56, v[8:11]
s_waitcnt lgkmcnt(1)
ds_write_b128 v57, v[12:15]
ds_read_b128 v[32:35], v60 offset:0
ds_read_b128 v[36:39], v60 offset:1024
s_add_u32 s47, s46, 65536
s_waitcnt lgkmcnt(1)
buffer_store_dwordx4 v[32:35], v6, s[36:39], s47 offen sc1
s_add_u32 s47, s46, 98304
s_waitcnt lgkmcnt(0)
buffer_store_dwordx4 v[36:39], v6, s[36:39], s47 offen sc1
ds_read_b64_tr_b16 v[8:9], v5 offset:64
ds_read_b64_tr_b16 v[10:11], v5 offset:576
ds_read_b64_tr_b16 v[12:13], v5 offset:4160
ds_read_b64_tr_b16 v[14:15], v5 offset:4672
s_waitcnt lgkmcnt(2)
ds_write_b128 v56, v[8:11]
s_waitcnt lgkmcnt(1)
ds_write_b128 v57, v[12:15]
ds_read_b128 v[24:27], v60 offset:0
ds_read_b128 v[28:31], v60 offset:1024
s_add_u32 s47, s46, 131072
s_waitcnt lgkmcnt(1)
buffer_store_dwordx4 v[24:27], v6, s[36:39], s47 offen sc1
s_add_u32 s47, s46, 163840
s_waitcnt lgkmcnt(0)
buffer_store_dwordx4 v[28:31], v6, s[36:39], s47 offen sc1
ds_read_b64_tr_b16 v[8:9], v5 offset:96
ds_read_b64_tr_b16 v[10:11], v5 offset:608
ds_read_b64_tr_b16 v[12:13], v5 offset:4192
ds_read_b64_tr_b16 v[14:15], v5 offset:4704
s_waitcnt lgkmcnt(2)
ds_write_b128 v56, v[8:11]
s_waitcnt lgkmcnt(1)
ds_write_b128 v57, v[12:15]
ds_read_b128 v[32:35], v60 offset:0
ds_read_b128 v[36:39], v60 offset:1024
s_add_u32 s47, s46, 196608
s_waitcnt lgkmcnt(1)
buffer_store_dwordx4 v[32:35], v6, s[36:39], s47 offen sc1
s_add_u32 s47, s46, 229376
s_waitcnt lgkmcnt(0)
buffer_store_dwordx4 v[36:39], v6, s[36:39], s47 offen sc1
s_waitcnt vmcnt(8)
v_readfirstlane_b32 s58, v251
s_nop 0
s_cmp_lg_u32 s58, 0
s_cbranch_scc1 L_t1_nonce_37
s_load_dwordx2 s[60:61], s[0:1], 120
v_mov_b32 v250, 0
s_mov_b32 s59, 0
s_waitcnt lgkmcnt(0)
L_nonce_38:
global_load_dword v251, v250, s[60:61] sc1
s_waitcnt vmcnt(0)
v_readfirstlane_b32 s58, v251
s_add_u32 s59, s59, 1
s_cmp_lg_u32 s58, 0
s_cbranch_scc1 L_nonced_39
s_cmp_lt_u32 s59, 16384
s_cbranch_scc0 L_to_40
s_sleep 2
s_branch L_nonce_38
L_to_40:
L_nonced_39:
L_t1_nonce_37:
s_add_u32 s8, s32, 0x1220000
s_addc_u32 s9, s33, 0
s_mov_b32 s10, 0x2000
s_mov_b32 s11, 0x20000
s_lshl_b32 s47, s41, 5
s_add_u32 s47, s47, s40
s_lshl_b32 s47, s47, 2
s_add_u32 s47, s47, 0
v_mov_b32 v250, 0
v_mov_b32 v251, s58
s_waitcnt vmcnt(0)
s_mov_b64 exec, 1
buffer_store_dword v251, v250, s[8:11], s47 offen sc1
s_mov_b64 exec, -1
s_mul_i32 s7, s5, 24
s_add_u32 s7, s7, s6
s_lshr_b32 s40, s7, 2
s_and_b32 s41, s7, 3
s_load_dwordx2 s[8:9], s[0:1], 96
s_load_dwordx2 s[32:33], s[0:1], 128
s_mov_b32 s45, 3277
v_mul_u32_u24 v2, s45, v1
v_lshrrev_b32 v2, 16, v2
v_mul_u32_u24 v3, 20, v2
v_sub_u32 v3, v1, v3
v_mul_u32_u24 v2, 1280, v2
v_lshl_add_u32 v2, v3, 4, v2
s_mul_i32 s44, s40, 40960
s_mul_i32 s45, s41, 320
s_add_u32 s44, s44, s45
s_waitcnt lgkmcnt(0)
s_mov_b32 s10, 0x1e0000
s_mov_b32 s11, 0x20000
s_add_u32 s36, s32, 0x600000
s_addc_u32 s37, s33, 0
s_mov_b32 s38, 0x1e0000
s_mov_b32 s39, 0x20000
s_mov_b32 exec_hi, 0xfffffff
s_add_u32 m0, s43, 0
s_nop 0
buffer_load_dwordx4 v2, s[8:11], s44 offen lds
s_add_u32 m0, s43, 960
s_add_u32 s44, s44, 3840
s_nop 0
buffer_load_dwordx4 v2, s[8:11], s44 offen lds
s_add_u32 m0, s43, 1920
s_add_u32 s44, s44, 3840
s_nop 0
buffer_load_dwordx4 v2, s[8:11], s44 offen lds
s_add_u32 m0, s43, 2880
s_add_u32 s44, s44, 3840
s_nop 0
buffer_load_dwordx4 v2, s[8:11], s44 offen lds
s_add_u32 m0, s43, 3840
s_add_u32 s44, s44, 3840
s_nop 0
buffer_load_dwordx4 v2, s[8:11], s44 offen lds
s_add_u32 m0, s43, 4800
s_add_u32 s44, s44, 3840
s_nop 0
buffer_load_dwordx4 v2, s[8:11], s44 offen lds
s_add_u32 m0, s43, 5760
s_add_u32 s44, s44, 3840
s_nop 0
buffer_load_dwordx4 v2, s[8:11], s44 offen lds
s_add_u32 m0, s43, 6720
s_add_u32 s44, s44, 3840
s_nop 0
buffer_load_dwordx4 v2, s[8:11], s44 offen lds
s_add_u32 m0, s43, 7680
s_add_u32 s44, s44, 3840
s_nop 0
buffer_load_dwordx4 v2, s[8:11], s44 offen lds
s_add_u32 m0, s43, 8640
s_add_u32 s44, s44, 3840
s_nop 0
buffer_load_dwordx4 v2, s[8:11], s44 offen lds
s_add_u32 m0, s43, 9600
s_add_u32 s44, s44, 3840
s_mov_b32 exec_hi, 0xff
s_nop 0
buffer_load_dwordx4 v2, s[8:11], s44 offen lds
s_mov_b64 exec, -1
v_lshrrev_b32 v4, 5, v1
v_lshlrev_b32 v4, 4, v4
v_bfe_u32 v5, v1, 4, 1
v_lshl_add_u32 v4, v5, 2, v4
v_bfe_u32 v5, v1, 2, 2
v_add_u32 v4, v4, v5
v_mul_u32_u24 v4, 320, v4
v_and_b32 v5, 3, v1
v_lshl_add_u32 v4, v5, 3, v4
v_add_u32 v4, s43, v4
v_lshlrev_b32 v6, 4, v1
s_mul_i32 s46, s41, 491520
s_mul_i32 s47, s40, 5120
s_add_u32 s46, s46, s47
s_waitcnt vmcnt(0)
ds_read_b64_tr_b16 v[8:9], v4 offset:0
ds_read_b64_tr_b16 v[10:11], v4 offset:2560
s_add_u32 s47, s46, 0
s_waitcnt lgkmcnt(0)
buffer_store_dwordx4 v[8:11], v6, s[36:39], s47 offen sc1
ds_read_b64_tr_b16 v[12:13], v4 offset:32
ds_read_b64_tr_b16 v[14:15], v4 offset:2592
s_add_u32 s47, s46, 1024
s_waitcnt lgkmcnt(0)
buffer_store_dwordx4 v[12:15], v6, s[36:39], s47 offen sc1
ds_read_b64_tr_b16 v[16:17], v4 offset:64
ds_read_b64_tr_b16 v[18:19], v4 offset:2624
s_add_u32 s47, s46, 2048
s_waitcnt lgkmcnt(0)
buffer_store_dwordx4 v[16:19], v6, s[36:39], s47 offen sc1
ds_read_b64_tr_b16 v[20:21], v4 offset:96
ds_read_b64_tr_b16 v[22:23], v4 offset:2656
s_add_u32 s47, s46, 3072
s_waitcnt lgkmcnt(0)
buffer_store_dwordx4 v[20:23], v6, s[36:39], s47 offen sc1
ds_read_b64_tr_b16 v[8:9], v4 offset:128
ds_read_b64_tr_b16 v[10:11], v4 offset:2688
s_add_u32 s47, s46, 4096
s_waitcnt lgkmcnt(0)
buffer_store_dwordx4 v[8:11], v6, s[36:39], s47 offen sc1
ds_read_b64_tr_b16 v[12:13], v4 offset:160
ds_read_b64_tr_b16 v[14:15], v4 offset:2720
s_add_u32 s47, s46, 245760
s_waitcnt lgkmcnt(0)
buffer_store_dwordx4 v[12:15], v6, s[36:39], s47 offen sc1
ds_read_b64_tr_b16 v[16:17], v4 offset:192
ds_read_b64_tr_b16 v[18:19], v4 offset:2752
s_add_u32 s47, s46, 246784
s_waitcnt lgkmcnt(0)
buffer_store_dwordx4 v[16:19], v6, s[36:39], s47 offen sc1
ds_read_b64_tr_b16 v[20:21], v4 offset:224
ds_read_b64_tr_b16 v[22:23], v4 offset:2784
s_add_u32 s47, s46, 247808
s_waitcnt lgkmcnt(0)
buffer_store_dwordx4 v[20:23], v6, s[36:39], s47 offen sc1
ds_read_b64_tr_b16 v[8:9], v4 offset:256
ds_read_b64_tr_b16 v[10:11], v4 offset:2816
s_add_u32 s47, s46, 248832
s_waitcnt lgkmcnt(0)
buffer_store_dwordx4 v[8:11], v6, s[36:39], s47 offen sc1
ds_read_b64_tr_b16 v[12:13], v4 offset:288
ds_read_b64_tr_b16 v[14:15], v4 offset:2848
s_add_u32 s47, s46, 249856
s_waitcnt lgkmcnt(0)
buffer_store_dwordx4 v[12:15], v6, s[36:39], s47 offen sc1
s_add_u32 s8, s32, 0x1220000
s_addc_u32 s9, s33, 0
s_mov_b32 s10, 0x2000
s_mov_b32 s11, 0x20000
s_mul_i32 s47, s41, 48
s_add_u32 s47, s47, s40
s_lshl_b32 s47, s47, 2
s_add_u32 s47, s47, 2048
v_mov_b32 v250, 0
v_mov_b32 v251, s58
s_waitcnt vmcnt(0)
s_mov_b64 exec, 1
buffer_store_dword v251, v250, s[8:11], s47 offen sc1
s_mov_b64 exec, -1
s_endpgm
L_taskB:
s_sub_u32 s43, s4, 2
s_mul_i32 s43, s43, 17152
s_add_u32 s43, s43, 47616
s_add_u32 s42, s6, 16
s_cmp_eq_u32 s4, 2
s_cselect_b32 s42, s6, s42
s_cmp_ge_u32 s42, 40
s_cbranch_scc1 L_taskB_pack
s_and_b32 s40, s5, 3
s_mul_i32 s40, s40, 40
s_add_u32 s7, s42, s40
s_mul_i32 s40, s7, 6554
s_lshr_b32 s40, s40, 16
s_mul_i32 s41, s40, 10
s_sub_u32 s41, s7, s41
s_lshr_b32 s3, s5, 2
s_lshl_b32 s3, s3, 4
s_add_u32 s40, s40, s3
s_load_dwordx2 s[8:9], s[0:1], 0
s_load_dwordx2 s[32:33], s[0:1], 128
s_load_dwordx2 s[60:61], s[0:1], 120
v_lshrrev_b32 v2, 3, v1
v_mul_u32_u24 v2, 1280, v2
v_and_b32 v3, 7, v1
v_lshl_add_u32 v2, v3, 4, v2
s_mul_i32 s44, s40, 81920
s_lshl_b32 s45, s41, 7
s_add_u32 s44, s44, s45
v_mov_b32 v250, 0
s_waitcnt lgkmcnt(0)
s_mov_b32 s10, 0x280000
s_mov_b32 s11, 0x20000
s_add_u32 s36, s32, 0x7e0000
s_addc_u32 s37, s33, 0
s_mov_b32 s38, 0x280000
s_mov_b32 s39, 0x20000
s_add_u32 m0, s43, 0
s_nop 0
buffer_load_dwordx4 v2, s[8:11], s44 offen lds
s_add_u32 m0, s43, 1024
s_add_u32 s44, s44, 10240
buffer_load_dwordx4 v2, s[8:11], s44 offen lds
s_add_u32 m0, s43, 2048
s_add_u32 s44, s44, 10240
buffer_load_dwordx4 v2, s[8:11], s44 offen lds
s_add_u32 m0, s43, 3072
s_add_u32 s44, s44, 10240
buffer_load_dwordx4 v2, s[8:11], s44 offen lds
s_add_u32 m0, s43, 4096
s_add_u32 s44, s44, 10240
buffer_load_dwordx4 v2, s[8:11], s44 offen lds
s_add_u32 m0, s43, 5120
s_add_u32 s44, s44, 10240
buffer_load_dwordx4 v2, s[8:11], s44 offen lds
s_add_u32 m0, s43, 6144
s_add_u32 s44, s44, 10240
buffer_load_dwordx4 v2, s[8:11], s44 offen lds
s_add_u32 m0, s43, 7168
s_add_u32 s44, s44, 10240
buffer_load_dwordx4 v2, s[8:11], s44 offen lds
global_load_dword v251, v250, s[60:61] sc1
v_lshrrev_b32 v4, 4, v1
v_bfe_u32 v5, v1, 2, 2
v_lshl_add_u32 v5, v4, 3, v5
v_lshlrev_b32 v5, 7, v5
v_and_b32 v6, 3, v1
v_lshl_add_u32 v5, v6, 3, v5
v_add_u32 v5, s43, v5
s_add_u32 s48, s43, 8192
v_and_b32 v6, 15, v1
v_and_b32 v7, 7, v6
v_xor_b32 v7, v7, v4
v_xor_b32 v3, 0, v7
v_lshlrev_b32 v3, 4, v3
v_lshl_add_u32 v56, v6, 7, v3
v_add_u32 v56, s48, v56
v_xor_b32 v3, 4, v7
v_lshlrev_b32 v3, 4, v3
v_lshl_add_u32 v57, v6, 7, v3
v_add_u32 v57, s48, v57
v_lshrrev_b32 v6, 3, v1
v_and_b32 v7, 7, v1
v_xor_b32 v3, v6, v7
v_lshlrev_b32 v3, 4, v3
v_lshl_add_u32 v60, v6, 7, v3
v_add_u32 v60, s48, v60
v_lshlrev_b32 v7, 4, v7
v_lshl_add_u32 v6, v6, 12, v7
s_lshl_b32 s46, s41, 18
s_lshl_b32 s47, s40, 7
s_add_u32 s46, s46, s47
s_waitcnt vmcnt(1)
ds_read_b64_tr_b16 v[8:9], v5 offset:0
ds_read_b64_tr_b16 v[10:11], v5 offset:512
ds_read_b64_tr_b16 v[12:13], v5 offset:4096
ds_read_b64_tr_b16 v[14:15], v5 offset:4608
s_waitcnt lgkmcnt(2)
ds_write_b128 v56, v[8:11]
s_waitcnt lgkmcnt(1)
ds_write_b128 v57, v[12:15]
ds_read_b128 v[24:27], v60 offset:0
ds_read_b128 v[28:31], v60 offset:1024
s_add_u32 s47, s46, 0
s_waitcnt lgkmcnt(1)
buffer_store_dwordx4 v[24:27], v6, s[36:39], s47 offen sc1
s_add_u32 s47, s46, 32768
s_waitcnt lgkmcnt(0)
buffer_store_dwordx4 v[28:31], v6, s[36:39], s47 offen sc1
ds_read_b64_tr_b16 v[8:9], v5 offset:32
ds_read_b64_tr_b16 v[10:11], v5 offset:544
ds_read_b64_tr_b16 v[12:13], v5 offset:4128
ds_read_b64_tr_b16 v[14:15], v5 offset:4640
s_waitcnt lgkmcnt(2)
ds_write_b128 v56, v[8:11]
s_waitcnt lgkmcnt(1)
ds_write_b128 v57, v[12:15]
ds_read_b128 v[32:35], v60 offset:0
ds_read_b128 v[36:39], v60 offset:1024
s_add_u32 s47, s46, 65536
s_waitcnt lgkmcnt(1)
buffer_store_dwordx4 v[32:35], v6, s[36:39], s47 offen sc1
s_add_u32 s47, s46, 98304
s_waitcnt lgkmcnt(0)
buffer_store_dwordx4 v[36:39], v6, s[36:39], s47 offen sc1
ds_read_b64_tr_b16 v[8:9], v5 offset:64
ds_read_b64_tr_b16 v[10:11], v5 offset:576
ds_read_b64_tr_b16 v[12:13], v5 offset:4160
ds_read_b64_tr_b16 v[14:15], v5 offset:4672
s_waitcnt lgkmcnt(2)
ds_write_b128 v56, v[8:11]
s_waitcnt lgkmcnt(1)
ds_write_b128 v57, v[12:15]
ds_read_b128 v[24:27], v60 offset:0
ds_read_b128 v[28:31], v60 offset:1024
s_add_u32 s47, s46, 131072
s_waitcnt lgkmcnt(1)
buffer_store_dwordx4 v[24:27], v6, s[36:39], s47 offen sc1
s_add_u32 s47, s46, 163840
s_waitcnt lgkmcnt(0)
buffer_store_dwordx4 v[28:31], v6, s[36:39], s47 offen sc1
ds_read_b64_tr_b16 v[8:9], v5 offset:96
ds_read_b64_tr_b16 v[10:11], v5 offset:608
ds_read_b64_tr_b16 v[12:13], v5 offset:4192
ds_read_b64_tr_b16 v[14:15], v5 offset:4704
s_waitcnt lgkmcnt(2)
ds_write_b128 v56, v[8:11]
s_waitcnt lgkmcnt(1)
ds_write_b128 v57, v[12:15]
ds_read_b128 v[32:35], v60 offset:0
ds_read_b128 v[36:39], v60 offset:1024
s_add_u32 s47, s46, 196608
s_waitcnt lgkmcnt(1)
buffer_store_dwordx4 v[32:35], v6, s[36:39], s47 offen sc1
s_add_u32 s47, s46, 229376
s_waitcnt lgkmcnt(0)
buffer_store_dwordx4 v[36:39], v6, s[36:39], s47 offen sc1
s_waitcnt vmcnt(8)
v_readfirstlane_b32 s58, v251
s_nop 0
s_cmp_lg_u32 s58, 0
s_cbranch_scc1 L_t1_nonce_41
s_load_dwordx2 s[60:61], s[0:1], 120
v_mov_b32 v250, 0
s_mov_b32 s59, 0
s_waitcnt lgkmcnt(0)
L_nonce_42:
global_load_dword v251, v250, s[60:61] sc1
s_waitcnt vmcnt(0)
v_readfirstlane_b32 s58, v251
s_add_u32 s59, s59, 1
s_cmp_lg_u32 s58, 0
s_cbranch_scc1 L_nonced_43
s_cmp_lt_u32 s59, 16384
s_cbranch_scc0 L_to_44
s_sleep 2
s_branch L_nonce_42
L_to_44:
L_nonced_43:
L_t1_nonce_41:
s_add_u32 s8, s32, 0x1220000
s_addc_u32 s9, s33, 0
s_mov_b32 s10, 0x2000
s_mov_b32 s11, 0x20000
s_lshl_b32 s47, s41, 5
s_add_u32 s47, s47, s40
s_lshl_b32 s47, s47, 2
s_add_u32 s47, s47, 0
v_mov_b32 v250, 0
v_mov_b32 v251, s58
s_waitcnt vmcnt(0)
s_mov_b64 exec, 1
buffer_store_dword v251, v250, s[8:11], s47 offen sc1
s_mov_b64 exec, -1
s_cmp_eq_u32 s4, 2
s_cbranch_scc0 L_taskB_end
s_sub_u32 s40, s6, 16
s_lshl_b32 s40, s40, 4
s_lshl_b32 s3, s5, 8
s_add_u32 s40, s40, s3
s_load_dwordx2 s[8:9], s[0:1], 0
s_load_dwordx2 s[12:13], s[0:1], 104
s_load_dwordx2 s[32:33], s[0:1], 128
v_lshlrev_b32 v2, 4, v1
v_lshlrev_b32 v3, 2, v1
v_add_u32 v3, 1024, v3
s_mul_i32 s44, s40, 1280
s_waitcnt lgkmcnt(0)
s_mov_b32 s10, 0x280000
s_mov_b32 s11, 0x20000
s_mov_b32 s14, 0x500
s_mov_b32 s15, 0x20000
s_add_u32 s36, s32, 0xf88000
s_addc_u32 s37, s33, 0
s_mov_b32 s38, 0x2000
s_mov_b32 s39, 0x20000
buffer_load_dwordx4 v[4:7], v2, s[12:15], 0 offen
buffer_load_dword v8, v3, s[12:15], 0 offen
buffer_load_dwordx4 v[16:19], v2, s[8:11], s44 offen
buffer_load_dword v20, v3, s[8:11], s44 offen
s_add_u32 s44, s44, 1280
buffer_load_dwordx4 v[24:27], v2, s[8:11], s44 offen
buffer_load_dword v28, v3, s[8:11], s44 offen
s_add_u32 s44, s44, 1280
buffer_load_dwordx4 v[32:35], v2, s[8:11], s44 offen
buffer_load_dword v36, v3, s[8:11], s44 offen
s_add_u32 s44, s44, 1280
buffer_load_dwordx4 v[40:43], v2, s[8:11], s44 offen
buffer_load_dword v44, v3, s[8:11], s44 offen
s_add_u32 s44, s44, 1280
buffer_load_dwordx4 v[48:51], v2, s[8:11], s44 offen
buffer_load_dword v52, v3, s[8:11], s44 offen
s_add_u32 s44, s44, 1280
buffer_load_dwordx4 v[56:59], v2, s[8:11], s44 offen
buffer_load_dword v60, v3, s[8:11], s44 offen
s_add_u32 s44, s44, 1280
buffer_load_dwordx4 v[64:67], v2, s[8:11], s44 offen
buffer_load_dword v68, v3, s[8:11], s44 offen
s_add_u32 s44, s44, 1280
buffer_load_dwordx4 v[72:75], v2, s[8:11], s44 offen
buffer_load_dword v76, v3, s[8:11], s44 offen
s_add_u32 s44, s44, 1280
buffer_load_dwordx4 v[80:83], v2, s[8:11], s44 offen
buffer_load_dword v84, v3, s[8:11], s44 offen
s_add_u32 s44, s44, 1280
buffer_load_dwordx4 v[88:91], v2, s[8:11], s44 offen
buffer_load_dword v92, v3, s[8:11], s44 offen
s_add_u32 s44, s44, 1280
buffer_load_dwordx4 v[96:99], v2, s[8:11], s44 offen
buffer_load_dword v100, v3, s[8:11], s44 offen
s_add_u32 s44, s44, 1280
buffer_load_dwordx4 v[104:107], v2, s[8:11], s44 offen
buffer_load_dword v108, v3, s[8:11], s44 offen
s_add_u32 s44, s44, 1280
buffer_load_dwordx4 v[112:115], v2, s[8:11], s44 offen
buffer_load_dword v116, v3, s[8:11], s44 offen
s_add_u32 s44, s44, 1280
buffer_load_dwordx4 v[120:123], v2, s[8:11], s44 offen
buffer_load_dword v124, v3, s[8:11], s44 offen
s_add_u32 s44, s44, 1280
buffer_load_dwordx4 v[128:131], v2, s[8:11], s44 offen
buffer_load_dword v132, v3, s[8:11], s44 offen
s_add_u32 s44, s44, 1280
buffer_load_dwordx4 v[136:139], v2, s[8:11], s44 offen
buffer_load_dword v140, v3, s[8:11], s44 offen
s_waitcnt vmcnt(30)
v_mov_b32 v21, 0
v_dot2_f32_bf16 v21, v16, v4, v21
v_dot2_f32_bf16 v21, v17, v5, v21
v_dot2_f32_bf16 v21, v18, v6, v21
v_dot2_f32_bf16 v21, v19, v7, v21
v_dot2_f32_bf16 v21, v20, v8, v21
s_waitcnt vmcnt(28)
v_mov_b32 v29, 0
v_dot2_f32_bf16 v29, v24, v4, v29
v_dot2_f32_bf16 v29, v25, v5, v29
v_dot2_f32_bf16 v29, v26, v6, v29
v_dot2_f32_bf16 v29, v27, v7, v29
v_dot2_f32_bf16 v29, v28, v8, v29
s_waitcnt vmcnt(26)
v_mov_b32 v37, 0
v_dot2_f32_bf16 v37, v32, v4, v37
v_dot2_f32_bf16 v37, v33, v5, v37
v_dot2_f32_bf16 v37, v34, v6, v37
v_dot2_f32_bf16 v37, v35, v7, v37
v_dot2_f32_bf16 v37, v36, v8, v37
s_waitcnt vmcnt(24)
v_mov_b32 v45, 0
v_dot2_f32_bf16 v45, v40, v4, v45
v_dot2_f32_bf16 v45, v41, v5, v45
v_dot2_f32_bf16 v45, v42, v6, v45
v_dot2_f32_bf16 v45, v43, v7, v45
v_dot2_f32_bf16 v45, v44, v8, v45
s_waitcnt vmcnt(22)
v_mov_b32 v53, 0
v_dot2_f32_bf16 v53, v48, v4, v53
v_dot2_f32_bf16 v53, v49, v5, v53
v_dot2_f32_bf16 v53, v50, v6, v53
v_dot2_f32_bf16 v53, v51, v7, v53
v_dot2_f32_bf16 v53, v52, v8, v53
s_waitcnt vmcnt(20)
v_mov_b32 v61, 0
v_dot2_f32_bf16 v61, v56, v4, v61
v_dot2_f32_bf16 v61, v57, v5, v61
v_dot2_f32_bf16 v61, v58, v6, v61
v_dot2_f32_bf16 v61, v59, v7, v61
v_dot2_f32_bf16 v61, v60, v8, v61
s_waitcnt vmcnt(18)
v_mov_b32 v69, 0
v_dot2_f32_bf16 v69, v64, v4, v69
v_dot2_f32_bf16 v69, v65, v5, v69
v_dot2_f32_bf16 v69, v66, v6, v69
v_dot2_f32_bf16 v69, v67, v7, v69
v_dot2_f32_bf16 v69, v68, v8, v69
s_waitcnt vmcnt(16)
v_mov_b32 v77, 0
v_dot2_f32_bf16 v77, v72, v4, v77
v_dot2_f32_bf16 v77, v73, v5, v77
v_dot2_f32_bf16 v77, v74, v6, v77
v_dot2_f32_bf16 v77, v75, v7, v77
v_dot2_f32_bf16 v77, v76, v8, v77
s_waitcnt vmcnt(14)
v_mov_b32 v85, 0
v_dot2_f32_bf16 v85, v80, v4, v85
v_dot2_f32_bf16 v85, v81, v5, v85
v_dot2_f32_bf16 v85, v82, v6, v85
v_dot2_f32_bf16 v85, v83, v7, v85
v_dot2_f32_bf16 v85, v84, v8, v85
s_waitcnt vmcnt(12)
v_mov_b32 v93, 0
v_dot2_f32_bf16 v93, v88, v4, v93
v_dot2_f32_bf16 v93, v89, v5, v93
v_dot2_f32_bf16 v93, v90, v6, v93
v_dot2_f32_bf16 v93, v91, v7, v93
v_dot2_f32_bf16 v93, v92, v8, v93
s_waitcnt vmcnt(10)
v_mov_b32 v101, 0
v_dot2_f32_bf16 v101, v96, v4, v101
v_dot2_f32_bf16 v101, v97, v5, v101
v_dot2_f32_bf16 v101, v98, v6, v101
v_dot2_f32_bf16 v101, v99, v7, v101
v_dot2_f32_bf16 v101, v100, v8, v101
s_waitcnt vmcnt(8)
v_mov_b32 v109, 0
v_dot2_f32_bf16 v109, v104, v4, v109
v_dot2_f32_bf16 v109, v105, v5, v109
v_dot2_f32_bf16 v109, v106, v6, v109
v_dot2_f32_bf16 v109, v107, v7, v109
v_dot2_f32_bf16 v109, v108, v8, v109
s_waitcnt vmcnt(6)
v_mov_b32 v117, 0
v_dot2_f32_bf16 v117, v112, v4, v117
v_dot2_f32_bf16 v117, v113, v5, v117
v_dot2_f32_bf16 v117, v114, v6, v117
v_dot2_f32_bf16 v117, v115, v7, v117
v_dot2_f32_bf16 v117, v116, v8, v117
s_waitcnt vmcnt(4)
v_mov_b32 v125, 0
v_dot2_f32_bf16 v125, v120, v4, v125
v_dot2_f32_bf16 v125, v121, v5, v125
v_dot2_f32_bf16 v125, v122, v6, v125
v_dot2_f32_bf16 v125, v123, v7, v125
v_dot2_f32_bf16 v125, v124, v8, v125
s_waitcnt vmcnt(2)
v_mov_b32 v133, 0
v_dot2_f32_bf16 v133, v128, v4, v133
v_dot2_f32_bf16 v133, v129, v5, v133
v_dot2_f32_bf16 v133, v130, v6, v133
v_dot2_f32_bf16 v133, v131, v7, v133
v_dot2_f32_bf16 v133, v132, v8, v133
s_waitcnt vmcnt(0)
v_mov_b32 v141, 0
v_dot2_f32_bf16 v141, v136, v4, v141
v_dot2_f32_bf16 v141, v137, v5, v141
v_dot2_f32_bf16 v141, v138, v6, v141
v_dot2_f32_bf16 v141, v139, v7, v141
v_dot2_f32_bf16 v141, v140, v8, v141
v_add_f32_dpp v21, v21, v21 row_shr:1 row_mask:0xf bank_mask:0xf
v_add_f32_dpp v29, v29, v29 row_shr:1 row_mask:0xf bank_mask:0xf
v_add_f32_dpp v37, v37, v37 row_shr:1 row_mask:0xf bank_mask:0xf
v_add_f32_dpp v45, v45, v45 row_shr:1 row_mask:0xf bank_mask:0xf
v_add_f32_dpp v53, v53, v53 row_shr:1 row_mask:0xf bank_mask:0xf
v_add_f32_dpp v61, v61, v61 row_shr:1 row_mask:0xf bank_mask:0xf
v_add_f32_dpp v69, v69, v69 row_shr:1 row_mask:0xf bank_mask:0xf
v_add_f32_dpp v77, v77, v77 row_shr:1 row_mask:0xf bank_mask:0xf
v_add_f32_dpp v85, v85, v85 row_shr:1 row_mask:0xf bank_mask:0xf
v_add_f32_dpp v93, v93, v93 row_shr:1 row_mask:0xf bank_mask:0xf
v_add_f32_dpp v101, v101, v101 row_shr:1 row_mask:0xf bank_mask:0xf
v_add_f32_dpp v109, v109, v109 row_shr:1 row_mask:0xf bank_mask:0xf
v_add_f32_dpp v117, v117, v117 row_shr:1 row_mask:0xf bank_mask:0xf
v_add_f32_dpp v125, v125, v125 row_shr:1 row_mask:0xf bank_mask:0xf
v_add_f32_dpp v133, v133, v133 row_shr:1 row_mask:0xf bank_mask:0xf
v_add_f32_dpp v141, v141, v141 row_shr:1 row_mask:0xf bank_mask:0xf
v_add_f32_dpp v21, v21, v21 row_shr:2 row_mask:0xf bank_mask:0xf
v_add_f32_dpp v29, v29, v29 row_shr:2 row_mask:0xf bank_mask:0xf
v_add_f32_dpp v37, v37, v37 row_shr:2 row_mask:0xf bank_mask:0xf
v_add_f32_dpp v45, v45, v45 row_shr:2 row_mask:0xf bank_mask:0xf
v_add_f32_dpp v53, v53, v53 row_shr:2 row_mask:0xf bank_mask:0xf
v_add_f32_dpp v61, v61, v61 row_shr:2 row_mask:0xf bank_mask:0xf
v_add_f32_dpp v69, v69, v69 row_shr:2 row_mask:0xf bank_mask:0xf
v_add_f32_dpp v77, v77, v77 row_shr:2 row_mask:0xf bank_mask:0xf
v_add_f32_dpp v85, v85, v85 row_shr:2 row_mask:0xf bank_mask:0xf
v_add_f32_dpp v93, v93, v93 row_shr:2 row_mask:0xf bank_mask:0xf
v_add_f32_dpp v101, v101, v101 row_shr:2 row_mask:0xf bank_mask:0xf
v_add_f32_dpp v109, v109, v109 row_shr:2 row_mask:0xf bank_mask:0xf
v_add_f32_dpp v117, v117, v117 row_shr:2 row_mask:0xf bank_mask:0xf
v_add_f32_dpp v125, v125, v125 row_shr:2 row_mask:0xf bank_mask:0xf
v_add_f32_dpp v133, v133, v133 row_shr:2 row_mask:0xf bank_mask:0xf
v_add_f32_dpp v141, v141, v141 row_shr:2 row_mask:0xf bank_mask:0xf
v_add_f32_dpp v21, v21, v21 row_shr:4 row_mask:0xf bank_mask:0xf
v_add_f32_dpp v29, v29, v29 row_shr:4 row_mask:0xf bank_mask:0xf
v_add_f32_dpp v37, v37, v37 row_shr:4 row_mask:0xf bank_mask:0xf
v_add_f32_dpp v45, v45, v45 row_shr:4 row_mask:0xf bank_mask:0xf
v_add_f32_dpp v53, v53, v53 row_shr:4 row_mask:0xf bank_mask:0xf
v_add_f32_dpp v61, v61, v61 row_shr:4 row_mask:0xf bank_mask:0xf
v_add_f32_dpp v69, v69, v69 row_shr:4 row_mask:0xf bank_mask:0xf
v_add_f32_dpp v77, v77, v77 row_shr:4 row_mask:0xf bank_mask:0xf
v_add_f32_dpp v85, v85, v85 row_shr:4 row_mask:0xf bank_mask:0xf
v_add_f32_dpp v93, v93, v93 row_shr:4 row_mask:0xf bank_mask:0xf
v_add_f32_dpp v101, v101, v101 row_shr:4 row_mask:0xf bank_mask:0xf
v_add_f32_dpp v109, v109, v109 row_shr:4 row_mask:0xf bank_mask:0xf
v_add_f32_dpp v117, v117, v117 row_shr:4 row_mask:0xf bank_mask:0xf
v_add_f32_dpp v125, v125, v125 row_shr:4 row_mask:0xf bank_mask:0xf
v_add_f32_dpp v133, v133, v133 row_shr:4 row_mask:0xf bank_mask:0xf
v_add_f32_dpp v141, v141, v141 row_shr:4 row_mask:0xf bank_mask:0xf
v_add_f32_dpp v21, v21, v21 row_shr:8 row_mask:0xf bank_mask:0xf
v_add_f32_dpp v29, v29, v29 row_shr:8 row_mask:0xf bank_mask:0xf
v_add_f32_dpp v37, v37, v37 row_shr:8 row_mask:0xf bank_mask:0xf
v_add_f32_dpp v45, v45, v45 row_shr:8 row_mask:0xf bank_mask:0xf
v_add_f32_dpp v53, v53, v53 row_shr:8 row_mask:0xf bank_mask:0xf
v_add_f32_dpp v61, v61, v61 row_shr:8 row_mask:0xf bank_mask:0xf
v_add_f32_dpp v69, v69, v69 row_shr:8 row_mask:0xf bank_mask:0xf
v_add_f32_dpp v77, v77, v77 row_shr:8 row_mask:0xf bank_mask:0xf
v_add_f32_dpp v85, v85, v85 row_shr:8 row_mask:0xf bank_mask:0xf
v_add_f32_dpp v93, v93, v93 row_shr:8 row_mask:0xf bank_mask:0xf
v_add_f32_dpp v101, v101, v101 row_shr:8 row_mask:0xf bank_mask:0xf
v_add_f32_dpp v109, v109, v109 row_shr:8 row_mask:0xf bank_mask:0xf
v_add_f32_dpp v117, v117, v117 row_shr:8 row_mask:0xf bank_mask:0xf
v_add_f32_dpp v125, v125, v125 row_shr:8 row_mask:0xf bank_mask:0xf
v_add_f32_dpp v133, v133, v133 row_shr:8 row_mask:0xf bank_mask:0xf
v_add_f32_dpp v141, v141, v141 row_shr:8 row_mask:0xf bank_mask:0xf
v_add_f32_dpp v21, v21, v21 row_bcast:15 row_mask:0xa bank_mask:0xf
v_add_f32_dpp v29, v29, v29 row_bcast:15 row_mask:0xa bank_mask:0xf
v_add_f32_dpp v37, v37, v37 row_bcast:15 row_mask:0xa bank_mask:0xf
v_add_f32_dpp v45, v45, v45 row_bcast:15 row_mask:0xa bank_mask:0xf
v_add_f32_dpp v53, v53, v53 row_bcast:15 row_mask:0xa bank_mask:0xf
v_add_f32_dpp v61, v61, v61 row_bcast:15 row_mask:0xa bank_mask:0xf
v_add_f32_dpp v69, v69, v69 row_bcast:15 row_mask:0xa bank_mask:0xf
v_add_f32_dpp v77, v77, v77 row_bcast:15 row_mask:0xa bank_mask:0xf
v_add_f32_dpp v85, v85, v85 row_bcast:15 row_mask:0xa bank_mask:0xf
v_add_f32_dpp v93, v93, v93 row_bcast:15 row_mask:0xa bank_mask:0xf
v_add_f32_dpp v101, v101, v101 row_bcast:15 row_mask:0xa bank_mask:0xf
v_add_f32_dpp v109, v109, v109 row_bcast:15 row_mask:0xa bank_mask:0xf
v_add_f32_dpp v117, v117, v117 row_bcast:15 row_mask:0xa bank_mask:0xf
v_add_f32_dpp v125, v125, v125 row_bcast:15 row_mask:0xa bank_mask:0xf
v_add_f32_dpp v133, v133, v133 row_bcast:15 row_mask:0xa bank_mask:0xf
v_add_f32_dpp v141, v141, v141 row_bcast:15 row_mask:0xa bank_mask:0xf
v_add_f32_dpp v21, v21, v21 row_bcast:31 row_mask:0xc bank_mask:0xf
v_add_f32_dpp v29, v29, v29 row_bcast:31 row_mask:0xc bank_mask:0xf
v_add_f32_dpp v37, v37, v37 row_bcast:31 row_mask:0xc bank_mask:0xf
v_add_f32_dpp v45, v45, v45 row_bcast:31 row_mask:0xc bank_mask:0xf
v_add_f32_dpp v53, v53, v53 row_bcast:31 row_mask:0xc bank_mask:0xf
v_add_f32_dpp v61, v61, v61 row_bcast:31 row_mask:0xc bank_mask:0xf
v_add_f32_dpp v69, v69, v69 row_bcast:31 row_mask:0xc bank_mask:0xf
v_add_f32_dpp v77, v77, v77 row_bcast:31 row_mask:0xc bank_mask:0xf
v_add_f32_dpp v85, v85, v85 row_bcast:31 row_mask:0xc bank_mask:0xf
v_add_f32_dpp v93, v93, v93 row_bcast:31 row_mask:0xc bank_mask:0xf
v_add_f32_dpp v101, v101, v101 row_bcast:31 row_mask:0xc bank_mask:0xf
v_add_f32_dpp v109, v109, v109 row_bcast:31 row_mask:0xc bank_mask:0xf
v_add_f32_dpp v117, v117, v117 row_bcast:31 row_mask:0xc bank_mask:0xf
v_add_f32_dpp v125, v125, v125 row_bcast:31 row_mask:0xc bank_mask:0xf
v_add_f32_dpp v133, v133, v133 row_bcast:31 row_mask:0xc bank_mask:0xf
v_add_f32_dpp v141, v141, v141 row_bcast:31 row_mask:0xc bank_mask:0xf
v_mov_b32 v9, 0
v_readlane_b32 s16, v21, 63
v_readlane_b32 s17, v29, 63
v_readlane_b32 s18, v37, 63
v_readlane_b32 s19, v45, 63
v_readlane_b32 s20, v53, 63
v_readlane_b32 s21, v61, 63
v_readlane_b32 s22, v69, 63
v_readlane_b32 s23, v77, 63
v_readlane_b32 s24, v85, 63
v_readlane_b32 s25, v93, 63
v_readlane_b32 s26, v101, 63
v_readlane_b32 s27, v109, 63
v_readlane_b32 s28, v117, 63
v_readlane_b32 s29, v125, 63
v_readlane_b32 s30, v133, 63
v_readlane_b32 s31, v141, 63
v_writelane_b32 v9, s16, 0
v_writelane_b32 v9, s17, 1
v_writelane_b32 v9, s18, 2
v_writelane_b32 v9, s19, 3
v_writelane_b32 v9, s20, 4
v_writelane_b32 v9, s21, 5
v_writelane_b32 v9, s22, 6
v_writelane_b32 v9, s23, 7
v_writelane_b32 v9, s24, 8
v_writelane_b32 v9, s25, 9
v_writelane_b32 v9, s26, 10
v_writelane_b32 v9, s27, 11
v_writelane_b32 v9, s28, 12
v_writelane_b32 v9, s29, 13
v_writelane_b32 v9, s30, 14
v_writelane_b32 v9, s31, 15
v_cvt_pk_bf16_f32 v9, v9, v9
v_lshlrev_b32 v9, 16, v9
v_mul_f32 v9, 0xbfb8aa3b, v9
v_exp_f32 v9, v9
s_nop 0
v_add_f32 v9, 1.0, v9
v_rcp_f32 v9, v9
s_nop 0
v_cvt_pk_bf16_f32 v9, v9, v9
v_lshlrev_b32 v9, 16, v9
v_lshlrev_b32 v10, 2, v1
s_lshl_b32 s45, s40, 2
s_mov_b64 exec, 0xffff
buffer_store_dword v9, v10, s[36:39], s45 offen sc1
s_mov_b64 exec, -1
s_add_u32 s8, s32, 0x1220000
s_addc_u32 s9, s33, 0
s_mov_b32 s10, 0x2000
s_mov_b32 s11, 0x20000
s_lshr_b32 s47, s40, 4
s_lshl_b32 s47, s47, 2
s_add_u32 s47, s47, 1536
v_mov_b32 v250, 0
v_mov_b32 v251, s58
s_waitcnt vmcnt(0)
s_mov_b64 exec, 1
buffer_store_dword v251, v250, s[8:11], s47 offen sc1
s_mov_b64 exec, -1
s_branch L_taskB_end
L_taskB_pack:
s_sub_u32 s54, s6, 8
s_mul_i32 s7, s5, 24
s_add_u32 s7, s7, s54
s_lshr_b32 s40, s7, 2
s_and_b32 s41, s7, 3
s_load_dwordx2 s[8:9], s[0:1], 96
s_load_dwordx2 s[32:33], s[0:1], 128
s_load_dwordx2 s[60:61], s[0:1], 120
s_mov_b32 s45, 3277
v_mul_u32_u24 v2, s45, v1
v_lshrrev_b32 v2, 16, v2
v_mul_u32_u24 v3, 20, v2
v_sub_u32 v3, v1, v3
v_mul_u32_u24 v2, 1280, v2
v_lshl_add_u32 v2, v3, 4, v2
s_mul_i32 s44, s40, 40960
s_mul_i32 s45, s41, 320
s_add_u32 s44, s44, s45
s_waitcnt lgkmcnt(0)
s_mov_b32 s10, 0x1e0000
s_mov_b32 s11, 0x20000
s_add_u32 s36, s32, 0x600000
s_addc_u32 s37, s33, 0
s_mov_b32 s38, 0x1e0000
s_mov_b32 s39, 0x20000
s_mov_b32 exec_hi, 0xfffffff
s_add_u32 m0, s43, 0
s_nop 0
buffer_load_dwordx4 v2, s[8:11], s44 offen nt lds
s_add_u32 m0, s43, 960
s_add_u32 s44, s44, 3840
s_nop 0
buffer_load_dwordx4 v2, s[8:11], s44 offen nt lds
s_add_u32 m0, s43, 1920
s_add_u32 s44, s44, 3840
s_nop 0
buffer_load_dwordx4 v2, s[8:11], s44 offen nt lds
s_add_u32 m0, s43, 2880
s_add_u32 s44, s44, 3840
s_nop 0
buffer_load_dwordx4 v2, s[8:11], s44 offen nt lds
s_add_u32 m0, s43, 3840
s_add_u32 s44, s44, 3840
s_nop 0
buffer_load_dwordx4 v2, s[8:11], s44 offen nt lds
s_add_u32 m0, s43, 4800
s_add_u32 s44, s44, 3840
s_nop 0
buffer_load_dwordx4 v2, s[8:11], s44 offen nt lds
s_add_u32 m0, s43, 5760
s_add_u32 s44, s44, 3840
s_nop 0
buffer_load_dwordx4 v2, s[8:11], s44 offen nt lds
s_add_u32 m0, s43, 6720
s_add_u32 s44, s44, 3840
s_nop 0
buffer_load_dwordx4 v2, s[8:11], s44 offen nt lds
s_add_u32 m0, s43, 7680
s_add_u32 s44, s44, 3840
s_nop 0
buffer_load_dwordx4 v2, s[8:11], s44 offen nt lds
s_add_u32 m0, s43, 8640
s_add_u32 s44, s44, 3840
s_nop 0
buffer_load_dwordx4 v2, s[8:11], s44 offen nt lds
s_add_u32 m0, s43, 9600
s_add_u32 s44, s44, 3840
s_mov_b32 exec_hi, 0xff
s_nop 0
buffer_load_dwordx4 v2, s[8:11], s44 offen nt lds
s_mov_b64 exec, -1
v_mov_b32 v250, 0
global_load_dword v251, v250, s[60:61] sc1
v_lshrrev_b32 v4, 5, v1
v_lshlrev_b32 v4, 4, v4
v_bfe_u32 v5, v1, 4, 1
v_lshl_add_u32 v4, v5, 2, v4
v_bfe_u32 v5, v1, 2, 2
v_add_u32 v4, v4, v5
v_mul_u32_u24 v4, 320, v4
v_and_b32 v5, 3, v1
v_lshl_add_u32 v4, v5, 3, v4
v_add_u32 v4, s43, v4
v_lshlrev_b32 v6, 4, v1
s_mul_i32 s46, s41, 491520
s_mul_i32 s47, s40, 5120
s_add_u32 s46, s46, s47
s_waitcnt vmcnt(1)
ds_read_b64_tr_b16 v[8:9], v4 offset:0
ds_read_b64_tr_b16 v[10:11], v4 offset:2560
s_add_u32 s47, s46, 0
s_waitcnt lgkmcnt(0)
buffer_store_dwordx4 v[8:11], v6, s[36:39], s47 offen sc1
ds_read_b64_tr_b16 v[12:13], v4 offset:32
ds_read_b64_tr_b16 v[14:15], v4 offset:2592
s_add_u32 s47, s46, 1024
s_waitcnt lgkmcnt(0)
buffer_store_dwordx4 v[12:15], v6, s[36:39], s47 offen sc1
ds_read_b64_tr_b16 v[16:17], v4 offset:64
ds_read_b64_tr_b16 v[18:19], v4 offset:2624
s_add_u32 s47, s46, 2048
s_waitcnt lgkmcnt(0)
buffer_store_dwordx4 v[16:19], v6, s[36:39], s47 offen sc1
ds_read_b64_tr_b16 v[20:21], v4 offset:96
ds_read_b64_tr_b16 v[22:23], v4 offset:2656
s_add_u32 s47, s46, 3072
s_waitcnt lgkmcnt(0)
buffer_store_dwordx4 v[20:23], v6, s[36:39], s47 offen sc1
ds_read_b64_tr_b16 v[8:9], v4 offset:128
ds_read_b64_tr_b16 v[10:11], v4 offset:2688
s_add_u32 s47, s46, 4096
s_waitcnt lgkmcnt(0)
buffer_store_dwordx4 v[8:11], v6, s[36:39], s47 offen sc1
ds_read_b64_tr_b16 v[12:13], v4 offset:160
ds_read_b64_tr_b16 v[14:15], v4 offset:2720
s_add_u32 s47, s46, 245760
s_waitcnt lgkmcnt(0)
buffer_store_dwordx4 v[12:15], v6, s[36:39], s47 offen sc1
ds_read_b64_tr_b16 v[16:17], v4 offset:192
ds_read_b64_tr_b16 v[18:19], v4 offset:2752
s_add_u32 s47, s46, 246784
s_waitcnt lgkmcnt(0)
buffer_store_dwordx4 v[16:19], v6, s[36:39], s47 offen sc1
ds_read_b64_tr_b16 v[20:21], v4 offset:224
ds_read_b64_tr_b16 v[22:23], v4 offset:2784
s_add_u32 s47, s46, 247808
s_waitcnt lgkmcnt(0)
buffer_store_dwordx4 v[20:23], v6, s[36:39], s47 offen sc1
ds_read_b64_tr_b16 v[8:9], v4 offset:256
ds_read_b64_tr_b16 v[10:11], v4 offset:2816
s_add_u32 s47, s46, 248832
s_waitcnt lgkmcnt(0)
buffer_store_dwordx4 v[8:11], v6, s[36:39], s47 offen sc1
ds_read_b64_tr_b16 v[12:13], v4 offset:288
ds_read_b64_tr_b16 v[14:15], v4 offset:2848
s_add_u32 s47, s46, 249856
s_waitcnt lgkmcnt(0)
buffer_store_dwordx4 v[12:15], v6, s[36:39], s47 offen sc1
s_waitcnt vmcnt(10)
v_readfirstlane_b32 s58, v251
s_nop 0
s_cmp_lg_u32 s58, 0
s_cbranch_scc1 L_t3_nonce_45
s_load_dwordx2 s[60:61], s[0:1], 120
v_mov_b32 v250, 0
s_mov_b32 s59, 0
s_waitcnt lgkmcnt(0)
L_nonce_46:
global_load_dword v251, v250, s[60:61] sc1
s_waitcnt vmcnt(0)
v_readfirstlane_b32 s58, v251
s_add_u32 s59, s59, 1
s_cmp_lg_u32 s58, 0
s_cbranch_scc1 L_nonced_47
s_cmp_lt_u32 s59, 16384
s_cbranch_scc0 L_to_48
s_sleep 2
s_branch L_nonce_46
L_to_48:
L_nonced_47:
L_t3_nonce_45:
s_add_u32 s8, s32, 0x1220000
s_addc_u32 s9, s33, 0
s_mov_b32 s10, 0x2000
s_mov_b32 s11, 0x20000
s_mul_i32 s47, s41, 48
s_add_u32 s47, s47, s40
s_lshl_b32 s47, s47, 2
s_add_u32 s47, s47, 2048
v_mov_b32 v250, 0
v_mov_b32 v251, s58
s_waitcnt vmcnt(0)
s_mov_b64 exec, 1
buffer_store_dword v251, v250, s[8:11], s47 offen sc1
s_mov_b64 exec, -1
L_taskB_end:
L_exit:
s_endpgm
.section .rodata,"a"
.p2align 6
.amdhsa_kernel gated_mix__ssm_conv_s4__swiglu_ffn__prompt_kernel
  .amdhsa_next_free_vgpr 256
  .amdhsa_next_free_sgpr 100
  .amdhsa_accum_offset 256
  .amdhsa_group_segment_fixed_size 0
  .amdhsa_kernarg_size 136
  .amdhsa_user_sgpr_count 2
  .amdhsa_user_sgpr_kernarg_segment_ptr 1
  .amdhsa_system_sgpr_workgroup_id_x 1
.end_amdhsa_kernel
.text
```
